```python
import torch

def _softmax(x, axis=-1):
    return torch.softmax(x, dim=axis)
def _gelu(x):
    return torch.nn.functional.gelu(x, approximate="tanh")
def _silu(x):
    return torch.nn.functional.silu(x)
def _sigmoid(x):
    return torch.sigmoid(x)
def _layernorm(x, axis=-1, eps=1e-5):
    m = x.mean(dim=axis, keepdim=True)
    v = x.var(dim=axis, keepdim=True, unbiased=False)
    return (x - m) / torch.sqrt(v + eps)
def _scatter_add(tgt, idx, src, axis=0):
    return tgt.clone().index_add_(axis, idx, src)
def _segment_sum(src, seg, n):
    out = torch.zeros((n,) + src.shape[1:], dtype=src.dtype)
    return out.index_add_(0, seg, src)
def _pad(x, pw):
    flat = tuple(v for pair in reversed(pw) for v in pair)
    return torch.nn.functional.pad(x, flat)

kernel_name = 'parallel_sum__mha_block_cached__swiglu_ffn__decode'

def setup_inputs():

    _w = (lambda a: (lambda t: t.to(torch.bfloat16) if t.is_floating_point() else t)(torch.as_tensor(a)))
    def _A_setup():
        B, Sq, D = 2, 1, 448
        H, Sk, Dh = 16, 8192, 256
        return {
            "x": _w((lambda *s: torch.randn(*s, dtype=torch.bfloat16) * 0.05)(B, Sq, D)),
            "k_cache": _w((lambda *s: torch.randn(*s, dtype=torch.bfloat16) * 3.2)(B, H, Sk, Dh)),
            "v_cache": _w((lambda *s: torch.randn(*s, dtype=torch.bfloat16) * 1.6)(B, H, Sk, Dh)),
            "wq": _w((lambda *s: torch.randn(*s, dtype=torch.bfloat16) * 3.2)(D, H * Dh) * (D ** -0.5)),
            "wo": _w((lambda *s: torch.randn(*s, dtype=torch.bfloat16) * 1.6)(H * Dh, D) * ((H * Dh) ** -0.5)),
        }
    _A_in = _A_setup()

    def _B_setup():
        B, S, D, F = 2, 1, 448, 1792
        return {
            "x": _w((lambda *s: torch.randn(*s, dtype=torch.bfloat16) * 0.05)(B, S, D)),
            "w_gate": _w((lambda *s: torch.randn(*s, dtype=torch.bfloat16) * 0.05)(D, F)),
            "w_up": _w((lambda *s: torch.randn(*s, dtype=torch.bfloat16) * 0.05)(D, F)),
            "w_down": _w((lambda *s: torch.randn(*s, dtype=torch.bfloat16) * 0.05)(F, D)),
        }
    _B_in = _B_setup()

    return {
        "A_x": _A_in["x"],
        "A_k_cache": _A_in["k_cache"],
        "A_v_cache": _A_in["v_cache"],
        "A_wq": _A_in["wq"],
        "A_wo": _A_in["wo"],
        "B_x": _B_in["x"],
        "B_w_gate": _B_in["w_gate"],
        "B_w_up": _B_in["w_up"],
        "B_w_down": _B_in["w_down"],
    }

def reference(A_x, A_k_cache, A_v_cache, A_wq, A_wo, B_x, B_w_gate, B_w_up, B_w_down):
    def _A_ref(x, k_cache, v_cache, wq, wo):
        B, Sq, D = x.shape
        H, Dh = 16, 256
        q = (lambda x, *d: x.permute(*d))((x @ wq).reshape(B, Sq, H, Dh), 0, 2, 1, 3)
        scores = torch.einsum("bhqd,bhkd->bhqk", q, k_cache) * (Dh ** -0.5)
        p = _softmax(scores, axis=-1)
        o = torch.einsum("bhqk,bhkd->bhqd", p, v_cache)
        return (lambda x, *d: x.permute(*d))(o, 0, 2, 1, 3).reshape(B, Sq, H * Dh) @ wo

    def _B_ref(x, w_gate, w_up, w_down):
        g = _silu(x @ w_gate)
        u = x @ w_up
        return (g * u) @ w_down

    x = A_x
    xn = _layernorm(x, axis=-1)
    return x + _A_ref(xn, A_k_cache, A_v_cache, A_wq, A_wo) + _B_ref(xn, B_w_gate, B_w_up, B_w_down)
```

```asm
; @launch kernel=k1_kernel grid=(256,1,1) block=(512,1,1) lds=105216
; @launch kernel=k2_kernel grid=(56,1,1) block=(256,1,1) lds=2048
.amdgcn_target "amdgcn-amd-amdhsa--gfx950"
.text
.p2align 8
.globl k1_kernel
.type k1_kernel,@function
k1_kernel:
    s_cmp_ge_u32 s2, 256
    s_cbranch_scc1 K1_END
    s_load_dwordx16 s[16:31], s[0:1], 0
    s_load_dwordx8 s[32:39], s[0:1], 64
    s_and_b32 s12, s2, 7
    s_lshr_b32 s11, s2, 3
    s_lshr_b32 s15, s11, 4
    s_lshl_b32 s5, s12, 1
    s_add_u32 s5, s5, s15
    s_lshr_b32 s8, s11, 3
    s_and_b32 s8, s8, 1
    s_and_b32 s9, s11, 7
    s_lshl_b32 s13, s8, 4
    s_add_u32 s13, s13, s5
    s_lshl_b32 s13, s13, 3
    s_add_u32 s13, s13, s9
    s_mov_b32 s14, 0x3db8aa3b
    s_mov_b32 s6, -1
    s_mov_b32 s7, 0x00ffffff
    v_and_b32 v62, 63, v0
    v_lshrrev_b32 v4, 6, v0
    s_nop 0
    v_readfirstlane_b32 s4, v4
    v_lshrrev_b32 v63, 4, v62
    v_and_b32 v64, 15, v62
    s_lshl_b32 s15, s13, 10
    s_lshl_b32 s3, s4, 7
    s_add_u32 s15, s15, s3
    v_add_u32 v4, s15, v63
    v_lshlrev_b32 v4, 9, v4
    v_lshl_add_u32 v1, v64, 4, v4
    s_lshl_b32 s15, s5, 8
    s_lshl_b32 s3, s4, 5
    s_add_u32 s15, s15, s3
    s_mul_i32 s15, s15, 896
    v_lshlrev_b32 v65, 4, v62
    v_add_u32 v3, s15, v65
    v_lshrrev_b32 v4, 1, v63
    v_lshlrev_b32 v4, 9, v4
    v_lshl_add_u32 v4, v64, 5, v4
    v_and_b32 v5, 1, v63
    v_lshl_add_u32 v4, v5, 4, v4
    s_lshl_b32 s15, s4, 10
    v_add_u32 v71, s15, v4
    v_mov_b32 v36, 0
    v_mov_b32 v37, 0
    v_mov_b32 v38, 0
    v_mov_b32 v39, 0
    v_mov_b32 v40, 0
    v_mov_b32 v41, 0
    v_mov_b32 v42, 0
    v_mov_b32 v43, 0
    s_and_b32 s100, s11, 15
    v_lshlrev_b32 v4, 13, v63
    s_lshl_b32 s15, s5, 9
    v_add_u32 v4, s15, v4
    v_lshl_add_u32 v2, v64, 4, v4
    s_min_u32 s10, s2, 223
    s_mul_hi_u32 s89, s10, 153391690
    s_mul_i32 s15, s89, 28
    s_sub_u32 s88, s10, s15
    s_mul_i32 s15, s89, 56
    s_lshl_b32 s3, s4, 3
    s_add_u32 s15, s15, s3
    v_lshrrev_b32 v70, 3, v62
    v_add_u32 v70, s15, v70
    s_mov_b32 s15, 3584
    v_mul_lo_u32 v72, s15, v70
    v_and_b32 v4, 7, v62
    v_lshl_add_u32 v72, v4, 4, v72
    s_lshl_b32 s15, s88, 7
    v_add_u32 v72, s15, v72
    s_mul_i32 s15, s4, 3584
    v_lshlrev_b32 v68, 5, v62
    v_add_u32 v68, s15, v68
    s_waitcnt lgkmcnt(0)
    s_mov_b32 s40, s16
    s_and_b32 s41, s17, 0xffff
    s_mov_b32 s42, 0x700
    s_mov_b32 s43, 0x00020000
    s_mov_b32 s52, s22
    s_and_b32 s53, s23, 0xffff
    s_mov_b32 s54, 0x380000
    s_mov_b32 s55, 0x00020000
    s_mov_b32 s60, s28
    s_and_b32 s61, s29, 0xffff
    s_mov_b32 s62, 0x188000
    s_mov_b32 s63, 0x00020000
    s_mov_b32 s64, s30
    s_and_b32 s65, s31, 0xffff
    s_mov_b32 s66, 0x188000
    s_mov_b32 s67, 0x00020000
    s_mov_b32 s68, s32
    s_and_b32 s69, s33, 0xffff
    s_mov_b32 s70, 0x188000
    s_mov_b32 s71, 0x00020000
    s_mov_b32 s84, s36
    s_and_b32 s85, s37, 0xffff
    s_mov_b32 s86, 0x100
    s_mov_b32 s87, 0x00020000
    s_mov_b32 s44, s18
    s_and_b32 s45, s19, 0xffff
    s_mov_b32 s46, 0x8000000
    s_mov_b32 s47, 0x00020000
    s_mov_b32 s48, s20
    s_and_b32 s49, s21, 0xffff
    s_mov_b32 s50, 0x8000000
    s_mov_b32 s51, 0x00020000
    s_mov_b32 s56, s24
    s_and_b32 s57, s25, 0xffff
    s_mov_b32 s58, 0x380000
    s_mov_b32 s59, 0x00020000
    s_mov_b32 s72, s38
    s_and_b32 s73, s39, 0xffff
    s_mov_b32 s74, 0x2c0000
    s_mov_b32 s75, 0x00020000
    s_mov_b64 exec, s[6:7]
    buffer_load_dwordx4 v[36:39], v65, s[40:43], 0 offen
    buffer_load_dwordx4 v[40:43], v65, s[40:43], 0 offen offset:896
    s_mov_b64 exec, -1
    s_mul_i32 s15, s100, 7
    s_add_u32 s15, s15, s4
    s_add_u32 s16, s15, 0
    s_cmp_ge_u32 s16, 112
    s_cselect_b32 s3, 112, 0
    s_sub_u32 s16, s16, s3
    s_add_u32 s17, s15, 8
    s_cmp_ge_u32 s17, 112
    s_cselect_b32 s3, 112, 0
    s_sub_u32 s17, s17, s3
    s_add_u32 s18, s15, 16
    s_cmp_ge_u32 s18, 112
    s_cselect_b32 s3, 112, 0
    s_sub_u32 s18, s18, s3
    s_add_u32 s19, s15, 24
    s_cmp_ge_u32 s19, 112
    s_cselect_b32 s3, 112, 0
    s_sub_u32 s19, s19, s3
    s_add_u32 s20, s15, 32
    s_cmp_ge_u32 s20, 112
    s_cselect_b32 s3, 112, 0
    s_sub_u32 s20, s20, s3
    s_add_u32 s21, s15, 40
    s_cmp_ge_u32 s21, 112
    s_cselect_b32 s3, 112, 0
    s_sub_u32 s21, s21, s3
    s_add_u32 s22, s15, 48
    s_cmp_ge_u32 s22, 112
    s_cselect_b32 s3, 112, 0
    s_sub_u32 s22, s22, s3
    s_add_u32 s23, s15, 56
    s_cmp_ge_u32 s23, 112
    s_cselect_b32 s3, 112, 0
    s_sub_u32 s23, s23, s3
    s_add_u32 s24, s15, 64
    s_cmp_ge_u32 s24, 112
    s_cselect_b32 s3, 112, 0
    s_sub_u32 s24, s24, s3
    s_add_u32 s25, s15, 72
    s_cmp_ge_u32 s25, 112
    s_cselect_b32 s3, 112, 0
    s_sub_u32 s25, s25, s3
    s_add_u32 s26, s15, 80
    s_cmp_ge_u32 s26, 112
    s_cselect_b32 s3, 112, 0
    s_sub_u32 s26, s26, s3
    s_add_u32 s27, s15, 88
    s_cmp_ge_u32 s27, 112
    s_cselect_b32 s3, 112, 0
    s_sub_u32 s27, s27, s3
    s_add_u32 s28, s15, 96
    s_cmp_ge_u32 s28, 112
    s_cselect_b32 s3, 112, 0
    s_sub_u32 s28, s28, s3
    s_add_u32 s29, s15, 104
    s_cmp_ge_u32 s29, 112
    s_cselect_b32 s3, 112, 0
    s_sub_u32 s29, s29, s3
    s_lshl_b32 s15, s16, 15
    buffer_load_dwordx4 v[80:83], v2, s[52:55], s15 offen
    buffer_load_dwordx4 v[84:87], v2, s[52:55], s15 offen offset:256
    buffer_load_dwordx4 v[252:255], v72, s[60:63], 0 offen nt
    buffer_load_dwordx4 v[248:251], v72, s[64:67], 0 offen nt
    buffer_load_dwordx4 v[88:91], v1, s[44:47], 0 offen nt
    buffer_load_dwordx4 v[92:95], v1, s[44:47], 0 offen offset:256 nt
    buffer_load_dwordx4 v[96:99], v1, s[44:47], 0 offen offset:2048 nt
    buffer_load_dwordx4 v[100:103], v1, s[44:47], 0 offen offset:2304 nt
    s_waitcnt vmcnt(8)
    v_lshlrev_b32 v12, 16, v36
    v_and_b32 v13, 0xffff0000, v36
    v_lshlrev_b32 v14, 16, v37
    v_and_b32 v15, 0xffff0000, v37
    v_lshlrev_b32 v16, 16, v38
    v_and_b32 v17, 0xffff0000, v38
    v_lshlrev_b32 v18, 16, v39
    v_and_b32 v19, 0xffff0000, v39
    v_add_f32 v4, v12, v13
    v_add_f32 v7, v14, v15
    v_add_f32 v8, v16, v17
    v_add_f32 v9, v18, v19
    v_add_f32 v4, v4, v7
    v_add_f32 v8, v8, v9
    v_add_f32 v4, v4, v8
    s_nop 1
    v_add_f32_dpp v4, v4, v4 quad_perm:[1,0,3,2] row_mask:0xf bank_mask:0xf
    s_nop 1
    v_add_f32_dpp v4, v4, v4 quad_perm:[2,3,0,1] row_mask:0xf bank_mask:0xf
    s_nop 1
    v_add_f32_dpp v4, v4, v4 row_half_mirror row_mask:0xf bank_mask:0xf
    s_nop 1
    v_add_f32_dpp v4, v4, v4 row_mirror row_mask:0xf bank_mask:0xf
    v_mov_b32 v7, v4
    s_nop 1
    v_permlane16_swap_b32 v4, v7
    v_add_f32 v4, v4, v7
    v_mov_b32 v7, v4
    s_nop 1
    v_permlane32_swap_b32 v4, v7
    v_add_f32 v4, v4, v7
    v_mul_f32 v4, 0x3b124925, v4
    v_mov_b32 v8, 0
    v_sub_f32 v7, v12, v4
    v_fmac_f32 v8, v7, v7
    v_sub_f32 v7, v13, v4
    v_fmac_f32 v8, v7, v7
    v_sub_f32 v7, v14, v4
    v_fmac_f32 v8, v7, v7
    v_sub_f32 v7, v15, v4
    v_fmac_f32 v8, v7, v7
    v_sub_f32 v7, v16, v4
    v_fmac_f32 v8, v7, v7
    v_sub_f32 v7, v17, v4
    v_fmac_f32 v8, v7, v7
    v_sub_f32 v7, v18, v4
    v_fmac_f32 v8, v7, v7
    v_sub_f32 v7, v19, v4
    v_fmac_f32 v8, v7, v7
    v_cndmask_b32 v8, 0, v8, s[6:7]
    s_nop 1
    v_add_f32_dpp v8, v8, v8 quad_perm:[1,0,3,2] row_mask:0xf bank_mask:0xf
    s_nop 1
    v_add_f32_dpp v8, v8, v8 quad_perm:[2,3,0,1] row_mask:0xf bank_mask:0xf
    s_nop 1
    v_add_f32_dpp v8, v8, v8 row_half_mirror row_mask:0xf bank_mask:0xf
    s_nop 1
    v_add_f32_dpp v8, v8, v8 row_mirror row_mask:0xf bank_mask:0xf
    v_mov_b32 v7, v8
    s_nop 1
    v_permlane16_swap_b32 v8, v7
    v_add_f32 v8, v8, v7
    v_mov_b32 v7, v8
    s_nop 1
    v_permlane32_swap_b32 v8, v7
    v_add_f32 v8, v8, v7
    v_mul_f32 v8, 0x3b124925, v8
    v_cvt_pk_bf16_f32 v4, 0, v4
    v_cvt_pk_bf16_f32 v8, 0, v8
    v_add_f32 v8, 0x3727c5ac, v8
    v_cvt_pk_bf16_f32 v8, 0, v8
    v_sqrt_f32 v8, v8
    s_nop 0
    v_cvt_pk_bf16_f32 v8, 0, v8
    v_rcp_f32 v9, v8
    v_sub_f32 v7, v12, v4
    v_cvt_pk_bf16_f32 v7, 0, v7
    v_mul_f32 v10, v7, v9
    v_fma_f32 v11, -v10, v8, v7
    v_fma_f32 v10, v11, v9, v10
    v_cvt_pk_bf16_f32 v12, 0, v10
    v_sub_f32 v7, v13, v4
    v_cvt_pk_bf16_f32 v7, 0, v7
    v_mul_f32 v10, v7, v9
    v_fma_f32 v11, -v10, v8, v7
    v_fma_f32 v10, v11, v9, v10
    v_cvt_pk_bf16_f32 v13, 0, v10
    v_sub_f32 v7, v14, v4
    v_cvt_pk_bf16_f32 v7, 0, v7
    v_mul_f32 v10, v7, v9
    v_fma_f32 v11, -v10, v8, v7
    v_fma_f32 v10, v11, v9, v10
    v_cvt_pk_bf16_f32 v14, 0, v10
    v_sub_f32 v7, v15, v4
    v_cvt_pk_bf16_f32 v7, 0, v7
    v_mul_f32 v10, v7, v9
    v_fma_f32 v11, -v10, v8, v7
    v_fma_f32 v10, v11, v9, v10
    v_cvt_pk_bf16_f32 v15, 0, v10
    v_sub_f32 v7, v16, v4
    v_cvt_pk_bf16_f32 v7, 0, v7
    v_mul_f32 v10, v7, v9
    v_fma_f32 v11, -v10, v8, v7
    v_fma_f32 v10, v11, v9, v10
    v_cvt_pk_bf16_f32 v16, 0, v10
    v_sub_f32 v7, v17, v4
    v_cvt_pk_bf16_f32 v7, 0, v7
    v_mul_f32 v10, v7, v9
    v_fma_f32 v11, -v10, v8, v7
    v_fma_f32 v10, v11, v9, v10
    v_cvt_pk_bf16_f32 v17, 0, v10
    v_sub_f32 v7, v18, v4
    v_cvt_pk_bf16_f32 v7, 0, v7
    v_mul_f32 v10, v7, v9
    v_fma_f32 v11, -v10, v8, v7
    v_fma_f32 v10, v11, v9, v10
    v_cvt_pk_bf16_f32 v18, 0, v10
    v_sub_f32 v7, v19, v4
    v_cvt_pk_bf16_f32 v7, 0, v7
    v_mul_f32 v10, v7, v9
    v_fma_f32 v11, -v10, v8, v7
    v_fma_f32 v10, v11, v9, v10
    v_cvt_pk_bf16_f32 v19, 0, v10
    s_mov_b64 exec, s[6:7]
    ds_write_b128 v68, v[12:15] offset:47872
    ds_write_b128 v68, v[16:19] offset:47888
    s_mov_b64 exec, -1
    v_lshlrev_b32 v12, 16, v40
    v_and_b32 v13, 0xffff0000, v40
    v_lshlrev_b32 v14, 16, v41
    v_and_b32 v15, 0xffff0000, v41
    v_lshlrev_b32 v16, 16, v42
    v_and_b32 v17, 0xffff0000, v42
    v_lshlrev_b32 v18, 16, v43
    v_and_b32 v19, 0xffff0000, v43
    v_add_f32 v4, v12, v13
    v_add_f32 v7, v14, v15
    v_add_f32 v8, v16, v17
    v_add_f32 v9, v18, v19
    v_add_f32 v4, v4, v7
    v_add_f32 v8, v8, v9
    v_add_f32 v4, v4, v8
    s_nop 1
    v_add_f32_dpp v4, v4, v4 quad_perm:[1,0,3,2] row_mask:0xf bank_mask:0xf
    s_nop 1
    v_add_f32_dpp v4, v4, v4 quad_perm:[2,3,0,1] row_mask:0xf bank_mask:0xf
    s_nop 1
    v_add_f32_dpp v4, v4, v4 row_half_mirror row_mask:0xf bank_mask:0xf
    s_nop 1
    v_add_f32_dpp v4, v4, v4 row_mirror row_mask:0xf bank_mask:0xf
    v_mov_b32 v7, v4
    s_nop 1
    v_permlane16_swap_b32 v4, v7
    v_add_f32 v4, v4, v7
    v_mov_b32 v7, v4
    s_nop 1
    v_permlane32_swap_b32 v4, v7
    v_add_f32 v4, v4, v7
    v_mul_f32 v4, 0x3b124925, v4
    v_mov_b32 v8, 0
    v_sub_f32 v7, v12, v4
    v_fmac_f32 v8, v7, v7
    v_sub_f32 v7, v13, v4
    v_fmac_f32 v8, v7, v7
    v_sub_f32 v7, v14, v4
    v_fmac_f32 v8, v7, v7
    v_sub_f32 v7, v15, v4
    v_fmac_f32 v8, v7, v7
    v_sub_f32 v7, v16, v4
    v_fmac_f32 v8, v7, v7
    v_sub_f32 v7, v17, v4
    v_fmac_f32 v8, v7, v7
    v_sub_f32 v7, v18, v4
    v_fmac_f32 v8, v7, v7
    v_sub_f32 v7, v19, v4
    v_fmac_f32 v8, v7, v7
    v_cndmask_b32 v8, 0, v8, s[6:7]
    s_nop 1
    v_add_f32_dpp v8, v8, v8 quad_perm:[1,0,3,2] row_mask:0xf bank_mask:0xf
    s_nop 1
    v_add_f32_dpp v8, v8, v8 quad_perm:[2,3,0,1] row_mask:0xf bank_mask:0xf
    s_nop 1
    v_add_f32_dpp v8, v8, v8 row_half_mirror row_mask:0xf bank_mask:0xf
    s_nop 1
    v_add_f32_dpp v8, v8, v8 row_mirror row_mask:0xf bank_mask:0xf
    v_mov_b32 v7, v8
    s_nop 1
    v_permlane16_swap_b32 v8, v7
    v_add_f32 v8, v8, v7
    v_mov_b32 v7, v8
    s_nop 1
    v_permlane32_swap_b32 v8, v7
    v_add_f32 v8, v8, v7
    v_mul_f32 v8, 0x3b124925, v8
    v_cvt_pk_bf16_f32 v4, 0, v4
    v_cvt_pk_bf16_f32 v8, 0, v8
    v_add_f32 v8, 0x3727c5ac, v8
    v_cvt_pk_bf16_f32 v8, 0, v8
    v_sqrt_f32 v8, v8
    s_nop 0
    v_cvt_pk_bf16_f32 v8, 0, v8
    v_rcp_f32 v9, v8
    v_sub_f32 v7, v12, v4
    v_cvt_pk_bf16_f32 v7, 0, v7
    v_mul_f32 v10, v7, v9
    v_fma_f32 v11, -v10, v8, v7
    v_fma_f32 v10, v11, v9, v10
    v_cvt_pk_bf16_f32 v12, 0, v10
    v_sub_f32 v7, v13, v4
    v_cvt_pk_bf16_f32 v7, 0, v7
    v_mul_f32 v10, v7, v9
    v_fma_f32 v11, -v10, v8, v7
    v_fma_f32 v10, v11, v9, v10
    v_cvt_pk_bf16_f32 v13, 0, v10
    v_sub_f32 v7, v14, v4
    v_cvt_pk_bf16_f32 v7, 0, v7
    v_mul_f32 v10, v7, v9
    v_fma_f32 v11, -v10, v8, v7
    v_fma_f32 v10, v11, v9, v10
    v_cvt_pk_bf16_f32 v14, 0, v10
    v_sub_f32 v7, v15, v4
    v_cvt_pk_bf16_f32 v7, 0, v7
    v_mul_f32 v10, v7, v9
    v_fma_f32 v11, -v10, v8, v7
    v_fma_f32 v10, v11, v9, v10
    v_cvt_pk_bf16_f32 v15, 0, v10
    v_sub_f32 v7, v16, v4
    v_cvt_pk_bf16_f32 v7, 0, v7
    v_mul_f32 v10, v7, v9
    v_fma_f32 v11, -v10, v8, v7
    v_fma_f32 v10, v11, v9, v10
    v_cvt_pk_bf16_f32 v16, 0, v10
    v_sub_f32 v7, v17, v4
    v_cvt_pk_bf16_f32 v7, 0, v7
    v_mul_f32 v10, v7, v9
    v_fma_f32 v11, -v10, v8, v7
    v_fma_f32 v10, v11, v9, v10
    v_cvt_pk_bf16_f32 v17, 0, v10
    v_sub_f32 v7, v18, v4
    v_cvt_pk_bf16_f32 v7, 0, v7
    v_mul_f32 v10, v7, v9
    v_fma_f32 v11, -v10, v8, v7
    v_fma_f32 v10, v11, v9, v10
    v_cvt_pk_bf16_f32 v18, 0, v10
    v_sub_f32 v7, v19, v4
    v_cvt_pk_bf16_f32 v7, 0, v7
    v_mul_f32 v10, v7, v9
    v_fma_f32 v11, -v10, v8, v7
    v_fma_f32 v10, v11, v9, v10
    v_cvt_pk_bf16_f32 v19, 0, v10
    s_mov_b64 exec, s[6:7]
    ds_write_b128 v68, v[12:15] offset:49664
    ds_write_b128 v68, v[16:19] offset:49680
    s_mov_b64 exec, -1
    s_waitcnt vmcnt(6)
    s_lshl_b32 s15, s17, 15
    buffer_load_dwordx4 v[104:107], v2, s[52:55], s15 offen
    buffer_load_dwordx4 v[108:111], v2, s[52:55], s15 offen offset:256
    s_lshl_b32 s15, s18, 15
    buffer_load_dwordx4 v[112:115], v2, s[52:55], s15 offen
    buffer_load_dwordx4 v[116:119], v2, s[52:55], s15 offen offset:256
    s_lshl_b32 s15, s19, 15
    buffer_load_dwordx4 v[120:123], v2, s[52:55], s15 offen
    buffer_load_dwordx4 v[124:127], v2, s[52:55], s15 offen offset:256
    s_lshl_b32 s15, s20, 15
    buffer_load_dwordx4 v[128:131], v2, s[52:55], s15 offen
    buffer_load_dwordx4 v[132:135], v2, s[52:55], s15 offen offset:256
    s_lshl_b32 s15, s21, 15
    buffer_load_dwordx4 v[136:139], v2, s[52:55], s15 offen
    buffer_load_dwordx4 v[140:143], v2, s[52:55], s15 offen offset:256
    s_lshl_b32 s15, s22, 15
    buffer_load_dwordx4 v[144:147], v2, s[52:55], s15 offen
    buffer_load_dwordx4 v[148:151], v2, s[52:55], s15 offen offset:256
    s_lshl_b32 s15, s23, 15
    buffer_load_dwordx4 v[152:155], v2, s[52:55], s15 offen
    buffer_load_dwordx4 v[156:159], v2, s[52:55], s15 offen offset:256
    s_lshl_b32 s15, s24, 15
    buffer_load_dwordx4 v[160:163], v2, s[52:55], s15 offen
    buffer_load_dwordx4 v[164:167], v2, s[52:55], s15 offen offset:256
    s_lshl_b32 s15, s25, 15
    buffer_load_dwordx4 v[168:171], v2, s[52:55], s15 offen
    buffer_load_dwordx4 v[172:175], v2, s[52:55], s15 offen offset:256
    s_lshl_b32 s15, s26, 15
    buffer_load_dwordx4 v[176:179], v2, s[52:55], s15 offen
    buffer_load_dwordx4 v[180:183], v2, s[52:55], s15 offen offset:256
    s_lshl_b32 s15, s27, 15
    buffer_load_dwordx4 v[184:187], v2, s[52:55], s15 offen
    buffer_load_dwordx4 v[188:191], v2, s[52:55], s15 offen offset:256
    s_lshl_b32 s15, s28, 15
    buffer_load_dwordx4 v[192:195], v2, s[52:55], s15 offen
    buffer_load_dwordx4 v[196:199], v2, s[52:55], s15 offen offset:256
    s_lshl_b32 s15, s29, 15
    buffer_load_dwordx4 v[200:203], v2, s[52:55], s15 offen
    buffer_load_dwordx4 v[204:207], v2, s[52:55], s15 offen offset:256
    s_mov_b32 s3, 4096
    buffer_load_dwordx4 v[208:211], v1, s[44:47], s3 offen nt
    buffer_load_dwordx4 v[212:215], v1, s[44:47], s3 offen offset:256 nt
    buffer_load_dwordx4 v[216:219], v1, s[44:47], s3 offen offset:2048 nt
    buffer_load_dwordx4 v[220:223], v1, s[44:47], s3 offen offset:2304 nt
    s_mov_b32 s3, 8192
    buffer_load_dwordx4 v[224:227], v1, s[44:47], s3 offen nt
    buffer_load_dwordx4 v[228:231], v1, s[44:47], s3 offen offset:256 nt
    buffer_load_dwordx4 v[232:235], v1, s[44:47], s3 offen offset:2048 nt
    buffer_load_dwordx4 v[236:239], v1, s[44:47], s3 offen offset:2304 nt
    s_mov_b32 s3, 12288
    buffer_load_dwordx4 v[240:243], v1, s[44:47], s3 offen nt
    buffer_load_dwordx4 v[244:247], v1, s[44:47], s3 offen offset:256 nt
    s_mul_i32 s15, s4, 3584
    s_mul_i32 s3, s8, 1792
    v_lshlrev_b32 v5, 2, v70
    v_add_u32 v5, s15, v5
    ds_read_b32 v66, v5 offset:47872
    ds_read_b32 v67, v5 offset:49664
    s_add_u32 s15, s15, s3
    v_lshlrev_b32 v69, 2, v63
    v_add_u32 v69, s15, v69
    s_lshl_b32 s15, s16, 4
    v_add_u32 v6, s15, v69
    ds_read_b32 v36, v6 offset:47872
    s_lshl_b32 s15, s17, 4
    v_add_u32 v7, s15, v69
    ds_read_b32 v37, v7 offset:47872
    s_lshl_b32 s15, s18, 4
    v_add_u32 v6, s15, v69
    ds_read_b32 v38, v6 offset:47872
    s_lshl_b32 s15, s19, 4
    v_add_u32 v7, s15, v69
    ds_read_b32 v39, v7 offset:47872
    s_lshl_b32 s15, s20, 4
    v_add_u32 v6, s15, v69
    ds_read_b32 v40, v6 offset:47872
    s_lshl_b32 s15, s21, 4
    v_add_u32 v7, s15, v69
    ds_read_b32 v41, v7 offset:47872
    s_lshl_b32 s15, s22, 4
    v_add_u32 v6, s15, v69
    ds_read_b32 v42, v6 offset:47872
    s_lshl_b32 s15, s23, 4
    v_add_u32 v7, s15, v69
    ds_read_b32 v43, v7 offset:47872
    s_lshl_b32 s15, s24, 4
    v_add_u32 v6, s15, v69
    ds_read_b32 v44, v6 offset:47872
    s_lshl_b32 s15, s25, 4
    v_add_u32 v7, s15, v69
    ds_read_b32 v45, v7 offset:47872
    s_lshl_b32 s15, s26, 4
    v_add_u32 v6, s15, v69
    ds_read_b32 v46, v6 offset:47872
    s_lshl_b32 s15, s27, 4
    v_add_u32 v7, s15, v69
    ds_read_b32 v47, v7 offset:47872
    s_lshl_b32 s15, s28, 4
    v_add_u32 v6, s15, v69
    ds_read_b32 v48, v6 offset:47872
    s_lshl_b32 s15, s29, 4
    v_add_u32 v7, s15, v69
    ds_read_b32 v49, v7 offset:47872
    s_waitcnt lgkmcnt(0)
    v_cmp_gt_u32 vcc, 0x1c0, v0
    s_nop 1
    v_cndmask_b32 v66, 0, v66, vcc
    v_cndmask_b32 v67, 0, v67, vcc
    s_waitcnt vmcnt(40)
    s_lshl_b32 s15, s4, 10
    v_and_b32 v6, 7, v62
    v_lshlrev_b32 v6, 6, v6
    v_lshl_add_u32 v6, v63, 4, v6
    v_add_u32 v6, s15, v6
    v_lshrrev_b32 v4, 16, v66
    v_lshrrev_b32 v5, 16, v67
    v_dot2_f32_bf16 v20, v252, v4, 0
    v_dot2_f32_bf16 v21, v252, v66, 0
    v_dot2_f32_bf16 v28, v252, v5, 0
    v_dot2_f32_bf16 v29, v252, v67, 0
    v_dot2_f32_bf16 v22, v253, v4, 0
    v_dot2_f32_bf16 v23, v253, v66, 0
    v_dot2_f32_bf16 v30, v253, v5, 0
    v_dot2_f32_bf16 v31, v253, v67, 0
    v_dot2_f32_bf16 v24, v254, v4, 0
    v_dot2_f32_bf16 v25, v254, v66, 0
    v_dot2_f32_bf16 v32, v254, v5, 0
    v_dot2_f32_bf16 v33, v254, v67, 0
    v_dot2_f32_bf16 v26, v255, v4, 0
    v_dot2_f32_bf16 v27, v255, v66, 0
    v_dot2_f32_bf16 v34, v255, v5, 0
    v_dot2_f32_bf16 v35, v255, v67, 0
    v_add_f32_dpp v20, v20, v20 row_ror:8 row_mask:0xf bank_mask:0xf
    v_add_f32_dpp v21, v21, v21 row_ror:8 row_mask:0xf bank_mask:0xf
    v_add_f32_dpp v22, v22, v22 row_ror:8 row_mask:0xf bank_mask:0xf
    v_add_f32_dpp v23, v23, v23 row_ror:8 row_mask:0xf bank_mask:0xf
    v_add_f32_dpp v24, v24, v24 row_ror:8 row_mask:0xf bank_mask:0xf
    v_add_f32_dpp v25, v25, v25 row_ror:8 row_mask:0xf bank_mask:0xf
    v_add_f32_dpp v26, v26, v26 row_ror:8 row_mask:0xf bank_mask:0xf
    v_add_f32_dpp v27, v27, v27 row_ror:8 row_mask:0xf bank_mask:0xf
    v_add_f32_dpp v28, v28, v28 row_ror:8 row_mask:0xf bank_mask:0xf
    v_add_f32_dpp v29, v29, v29 row_ror:8 row_mask:0xf bank_mask:0xf
    v_add_f32_dpp v30, v30, v30 row_ror:8 row_mask:0xf bank_mask:0xf
    v_add_f32_dpp v31, v31, v31 row_ror:8 row_mask:0xf bank_mask:0xf
    v_add_f32_dpp v32, v32, v32 row_ror:8 row_mask:0xf bank_mask:0xf
    v_add_f32_dpp v33, v33, v33 row_ror:8 row_mask:0xf bank_mask:0xf
    v_add_f32_dpp v34, v34, v34 row_ror:8 row_mask:0xf bank_mask:0xf
    v_add_f32_dpp v35, v35, v35 row_ror:8 row_mask:0xf bank_mask:0xf
    v_permlane32_swap_b32 v20, v28
    v_permlane32_swap_b32 v21, v29
    v_permlane32_swap_b32 v22, v30
    v_permlane32_swap_b32 v23, v31
    v_permlane32_swap_b32 v24, v32
    v_permlane32_swap_b32 v25, v33
    v_permlane32_swap_b32 v26, v34
    v_permlane32_swap_b32 v27, v35
    v_add_f32 v20, v20, v28
    v_add_f32 v21, v21, v29
    v_add_f32 v22, v22, v30
    v_add_f32 v23, v23, v31
    v_add_f32 v24, v24, v32
    v_add_f32 v25, v25, v33
    v_add_f32 v26, v26, v34
    v_add_f32 v27, v27, v35
    v_permlane16_swap_b32 v20, v24
    v_permlane16_swap_b32 v21, v25
    v_permlane16_swap_b32 v22, v26
    v_permlane16_swap_b32 v23, v27
    v_add_f32 v20, v20, v24
    v_add_f32 v21, v21, v25
    v_add_f32 v22, v22, v26
    v_add_f32 v23, v23, v27
    ds_write_b128 v6, v[20:23] offset:39168
    v_dot2_f32_bf16 v12, v248, v4, 0
    v_dot2_f32_bf16 v13, v248, v66, 0
    v_dot2_f32_bf16 v52, v248, v5, 0
    v_dot2_f32_bf16 v53, v248, v67, 0
    v_dot2_f32_bf16 v14, v249, v4, 0
    v_dot2_f32_bf16 v15, v249, v66, 0
    v_dot2_f32_bf16 v54, v249, v5, 0
    v_dot2_f32_bf16 v55, v249, v67, 0
    v_dot2_f32_bf16 v16, v250, v4, 0
    v_dot2_f32_bf16 v17, v250, v66, 0
    v_dot2_f32_bf16 v56, v250, v5, 0
    v_dot2_f32_bf16 v57, v250, v67, 0
    v_dot2_f32_bf16 v18, v251, v4, 0
    v_dot2_f32_bf16 v19, v251, v66, 0
    v_dot2_f32_bf16 v58, v251, v5, 0
    v_dot2_f32_bf16 v59, v251, v67, 0
    v_add_f32_dpp v12, v12, v12 row_ror:8 row_mask:0xf bank_mask:0xf
    v_add_f32_dpp v13, v13, v13 row_ror:8 row_mask:0xf bank_mask:0xf
    v_add_f32_dpp v14, v14, v14 row_ror:8 row_mask:0xf bank_mask:0xf
    v_add_f32_dpp v15, v15, v15 row_ror:8 row_mask:0xf bank_mask:0xf
    v_add_f32_dpp v16, v16, v16 row_ror:8 row_mask:0xf bank_mask:0xf
    v_add_f32_dpp v17, v17, v17 row_ror:8 row_mask:0xf bank_mask:0xf
    v_add_f32_dpp v18, v18, v18 row_ror:8 row_mask:0xf bank_mask:0xf
    v_add_f32_dpp v19, v19, v19 row_ror:8 row_mask:0xf bank_mask:0xf
    v_add_f32_dpp v52, v52, v52 row_ror:8 row_mask:0xf bank_mask:0xf
    v_add_f32_dpp v53, v53, v53 row_ror:8 row_mask:0xf bank_mask:0xf
    v_add_f32_dpp v54, v54, v54 row_ror:8 row_mask:0xf bank_mask:0xf
    v_add_f32_dpp v55, v55, v55 row_ror:8 row_mask:0xf bank_mask:0xf
    v_add_f32_dpp v56, v56, v56 row_ror:8 row_mask:0xf bank_mask:0xf
    v_add_f32_dpp v57, v57, v57 row_ror:8 row_mask:0xf bank_mask:0xf
    v_add_f32_dpp v58, v58, v58 row_ror:8 row_mask:0xf bank_mask:0xf
    v_add_f32_dpp v59, v59, v59 row_ror:8 row_mask:0xf bank_mask:0xf
    v_permlane32_swap_b32 v12, v52
    v_permlane32_swap_b32 v13, v53
    v_permlane32_swap_b32 v14, v54
    v_permlane32_swap_b32 v15, v55
    v_permlane32_swap_b32 v16, v56
    v_permlane32_swap_b32 v17, v57
    v_permlane32_swap_b32 v18, v58
    v_permlane32_swap_b32 v19, v59
    v_add_f32 v12, v12, v52
    v_add_f32 v13, v13, v53
    v_add_f32 v14, v14, v54
    v_add_f32 v15, v15, v55
    v_add_f32 v16, v16, v56
    v_add_f32 v17, v17, v57
    v_add_f32 v18, v18, v58
    v_add_f32 v19, v19, v59
    v_permlane16_swap_b32 v12, v16
    v_permlane16_swap_b32 v13, v17
    v_permlane16_swap_b32 v14, v18
    v_permlane16_swap_b32 v15, v19
    v_add_f32 v12, v12, v16
    v_add_f32 v13, v13, v17
    v_add_f32 v14, v14, v18
    v_add_f32 v15, v15, v19
    ds_write_b128 v6, v[12:15] offset:39680
    s_waitcnt lgkmcnt(0)
    v_mov_b32 v20, 0
    v_mov_b32 v21, 0
    v_mov_b32 v22, 0
    v_mov_b32 v23, 0
    v_mov_b32 v24, 0
    v_mov_b32 v25, 0
    v_mov_b32 v26, 0
    v_mov_b32 v27, 0
    v_mov_b32 v28, 0
    v_mov_b32 v29, 0
    v_mov_b32 v30, 0
    v_mov_b32 v31, 0
    v_mov_b32 v32, 0
    v_mov_b32 v33, 0
    v_mov_b32 v34, 0
    v_mov_b32 v35, 0
    v_lshrrev_b32 v4, 16, v36
    v_dot2c_f32_bf16 v20, v80, v4
    v_dot2c_f32_bf16 v21, v80, v36
    v_dot2c_f32_bf16 v28, v84, v4
    v_dot2c_f32_bf16 v29, v84, v36
    v_dot2c_f32_bf16 v22, v81, v4
    v_dot2c_f32_bf16 v23, v81, v36
    v_dot2c_f32_bf16 v30, v85, v4
    v_dot2c_f32_bf16 v31, v85, v36
    v_dot2c_f32_bf16 v24, v82, v4
    v_dot2c_f32_bf16 v25, v82, v36
    v_dot2c_f32_bf16 v32, v86, v4
    v_dot2c_f32_bf16 v33, v86, v36
    v_dot2c_f32_bf16 v26, v83, v4
    v_dot2c_f32_bf16 v27, v83, v36
    v_dot2c_f32_bf16 v34, v87, v4
    v_dot2c_f32_bf16 v35, v87, v36
    s_mov_b32 s3, 12288
    buffer_load_dwordx4 v[252:255], v1, s[44:47], s3 offen offset:2048 nt
    buffer_load_dwordx4 v[248:251], v1, s[44:47], s3 offen offset:2304 nt
    buffer_load_dwordx4 v[80:83], v1, s[48:51], 0 offen nt
    buffer_load_dwordx4 v[84:87], v1, s[48:51], 0 offen offset:256 nt
    s_waitcnt vmcnt(38)
    v_lshrrev_b32 v5, 16, v37
    v_dot2c_f32_bf16 v20, v104, v5
    v_dot2c_f32_bf16 v21, v104, v37
    v_dot2c_f32_bf16 v28, v108, v5
    v_dot2c_f32_bf16 v29, v108, v37
    v_dot2c_f32_bf16 v22, v105, v5
    v_dot2c_f32_bf16 v23, v105, v37
    v_dot2c_f32_bf16 v30, v109, v5
    v_dot2c_f32_bf16 v31, v109, v37
    v_dot2c_f32_bf16 v24, v106, v5
    v_dot2c_f32_bf16 v25, v106, v37
    v_dot2c_f32_bf16 v32, v110, v5
    v_dot2c_f32_bf16 v33, v110, v37
    v_dot2c_f32_bf16 v26, v107, v5
    v_dot2c_f32_bf16 v27, v107, v37
    v_dot2c_f32_bf16 v34, v111, v5
    v_dot2c_f32_bf16 v35, v111, v37
    buffer_load_dwordx4 v[104:107], v1, s[48:51], 0 offen offset:2048 nt
    buffer_load_dwordx4 v[108:111], v1, s[48:51], 0 offen offset:2304 nt
    s_waitcnt vmcnt(38)
    v_lshrrev_b32 v4, 16, v38
    v_dot2c_f32_bf16 v20, v112, v4
    v_dot2c_f32_bf16 v21, v112, v38
    v_dot2c_f32_bf16 v28, v116, v4
    v_dot2c_f32_bf16 v29, v116, v38
    v_dot2c_f32_bf16 v22, v113, v4
    v_dot2c_f32_bf16 v23, v113, v38
    v_dot2c_f32_bf16 v30, v117, v4
    v_dot2c_f32_bf16 v31, v117, v38
    v_dot2c_f32_bf16 v24, v114, v4
    v_dot2c_f32_bf16 v25, v114, v38
    v_dot2c_f32_bf16 v32, v118, v4
    v_dot2c_f32_bf16 v33, v118, v38
    v_dot2c_f32_bf16 v26, v115, v4
    v_dot2c_f32_bf16 v27, v115, v38
    v_dot2c_f32_bf16 v34, v119, v4
    v_dot2c_f32_bf16 v35, v119, v38
    s_mov_b32 s3, 4096
    buffer_load_dwordx4 v[112:115], v1, s[48:51], s3 offen nt
    buffer_load_dwordx4 v[116:119], v1, s[48:51], s3 offen offset:256 nt
    s_waitcnt vmcnt(38)
    v_lshrrev_b32 v5, 16, v39
    v_dot2c_f32_bf16 v20, v120, v5
    v_dot2c_f32_bf16 v21, v120, v39
    v_dot2c_f32_bf16 v28, v124, v5
    v_dot2c_f32_bf16 v29, v124, v39
    v_dot2c_f32_bf16 v22, v121, v5
    v_dot2c_f32_bf16 v23, v121, v39
    v_dot2c_f32_bf16 v30, v125, v5
    v_dot2c_f32_bf16 v31, v125, v39
    v_dot2c_f32_bf16 v24, v122, v5
    v_dot2c_f32_bf16 v25, v122, v39
    v_dot2c_f32_bf16 v32, v126, v5
    v_dot2c_f32_bf16 v33, v126, v39
    v_dot2c_f32_bf16 v26, v123, v5
    v_dot2c_f32_bf16 v27, v123, v39
    v_dot2c_f32_bf16 v34, v127, v5
    v_dot2c_f32_bf16 v35, v127, v39
    buffer_load_dwordx4 v[120:123], v1, s[48:51], s3 offen offset:2048 nt
    buffer_load_dwordx4 v[124:127], v1, s[48:51], s3 offen offset:2304 nt
    s_waitcnt vmcnt(38)
    v_lshrrev_b32 v4, 16, v40
    v_dot2c_f32_bf16 v20, v128, v4
    v_dot2c_f32_bf16 v21, v128, v40
    v_dot2c_f32_bf16 v28, v132, v4
    v_dot2c_f32_bf16 v29, v132, v40
    v_dot2c_f32_bf16 v22, v129, v4
    v_dot2c_f32_bf16 v23, v129, v40
    v_dot2c_f32_bf16 v30, v133, v4
    v_dot2c_f32_bf16 v31, v133, v40
    v_dot2c_f32_bf16 v24, v130, v4
    v_dot2c_f32_bf16 v25, v130, v40
    v_dot2c_f32_bf16 v32, v134, v4
    v_dot2c_f32_bf16 v33, v134, v40
    v_dot2c_f32_bf16 v26, v131, v4
    v_dot2c_f32_bf16 v27, v131, v40
    v_dot2c_f32_bf16 v34, v135, v4
    v_dot2c_f32_bf16 v35, v135, v40
    s_waitcnt vmcnt(36)
    v_lshrrev_b32 v5, 16, v41
    v_dot2c_f32_bf16 v20, v136, v5
    v_dot2c_f32_bf16 v21, v136, v41
    v_dot2c_f32_bf16 v28, v140, v5
    v_dot2c_f32_bf16 v29, v140, v41
    v_dot2c_f32_bf16 v22, v137, v5
    v_dot2c_f32_bf16 v23, v137, v41
    v_dot2c_f32_bf16 v30, v141, v5
    v_dot2c_f32_bf16 v31, v141, v41
    v_dot2c_f32_bf16 v24, v138, v5
    v_dot2c_f32_bf16 v25, v138, v41
    v_dot2c_f32_bf16 v32, v142, v5
    v_dot2c_f32_bf16 v33, v142, v41
    v_dot2c_f32_bf16 v26, v139, v5
    v_dot2c_f32_bf16 v27, v139, v41
    v_dot2c_f32_bf16 v34, v143, v5
    v_dot2c_f32_bf16 v35, v143, v41
    s_waitcnt vmcnt(34)
    v_lshrrev_b32 v4, 16, v42
    v_dot2c_f32_bf16 v20, v144, v4
    v_dot2c_f32_bf16 v21, v144, v42
    v_dot2c_f32_bf16 v28, v148, v4
    v_dot2c_f32_bf16 v29, v148, v42
    v_dot2c_f32_bf16 v22, v145, v4
    v_dot2c_f32_bf16 v23, v145, v42
    v_dot2c_f32_bf16 v30, v149, v4
    v_dot2c_f32_bf16 v31, v149, v42
    v_dot2c_f32_bf16 v24, v146, v4
    v_dot2c_f32_bf16 v25, v146, v42
    v_dot2c_f32_bf16 v32, v150, v4
    v_dot2c_f32_bf16 v33, v150, v42
    v_dot2c_f32_bf16 v26, v147, v4
    v_dot2c_f32_bf16 v27, v147, v42
    v_dot2c_f32_bf16 v34, v151, v4
    v_dot2c_f32_bf16 v35, v151, v42
    s_waitcnt vmcnt(32)
    v_lshrrev_b32 v5, 16, v43
    v_dot2c_f32_bf16 v20, v152, v5
    v_dot2c_f32_bf16 v21, v152, v43
    v_dot2c_f32_bf16 v28, v156, v5
    v_dot2c_f32_bf16 v29, v156, v43
    v_dot2c_f32_bf16 v22, v153, v5
    v_dot2c_f32_bf16 v23, v153, v43
    v_dot2c_f32_bf16 v30, v157, v5
    v_dot2c_f32_bf16 v31, v157, v43
    v_dot2c_f32_bf16 v24, v154, v5
    v_dot2c_f32_bf16 v25, v154, v43
    v_dot2c_f32_bf16 v32, v158, v5
    v_dot2c_f32_bf16 v33, v158, v43
    v_dot2c_f32_bf16 v26, v155, v5
    v_dot2c_f32_bf16 v27, v155, v43
    v_dot2c_f32_bf16 v34, v159, v5
    v_dot2c_f32_bf16 v35, v159, v43
    s_waitcnt vmcnt(30)
    v_lshrrev_b32 v4, 16, v44
    v_dot2c_f32_bf16 v20, v160, v4
    v_dot2c_f32_bf16 v21, v160, v44
    v_dot2c_f32_bf16 v28, v164, v4
    v_dot2c_f32_bf16 v29, v164, v44
    v_dot2c_f32_bf16 v22, v161, v4
    v_dot2c_f32_bf16 v23, v161, v44
    v_dot2c_f32_bf16 v30, v165, v4
    v_dot2c_f32_bf16 v31, v165, v44
    v_dot2c_f32_bf16 v24, v162, v4
    v_dot2c_f32_bf16 v25, v162, v44
    v_dot2c_f32_bf16 v32, v166, v4
    v_dot2c_f32_bf16 v33, v166, v44
    v_dot2c_f32_bf16 v26, v163, v4
    v_dot2c_f32_bf16 v27, v163, v44
    v_dot2c_f32_bf16 v34, v167, v4
    v_dot2c_f32_bf16 v35, v167, v44
    s_waitcnt vmcnt(28)
    v_lshrrev_b32 v5, 16, v45
    v_dot2c_f32_bf16 v20, v168, v5
    v_dot2c_f32_bf16 v21, v168, v45
    v_dot2c_f32_bf16 v28, v172, v5
    v_dot2c_f32_bf16 v29, v172, v45
    v_dot2c_f32_bf16 v22, v169, v5
    v_dot2c_f32_bf16 v23, v169, v45
    v_dot2c_f32_bf16 v30, v173, v5
    v_dot2c_f32_bf16 v31, v173, v45
    v_dot2c_f32_bf16 v24, v170, v5
    v_dot2c_f32_bf16 v25, v170, v45
    v_dot2c_f32_bf16 v32, v174, v5
    v_dot2c_f32_bf16 v33, v174, v45
    v_dot2c_f32_bf16 v26, v171, v5
    v_dot2c_f32_bf16 v27, v171, v45
    v_dot2c_f32_bf16 v34, v175, v5
    v_dot2c_f32_bf16 v35, v175, v45
    s_waitcnt vmcnt(26)
    v_lshrrev_b32 v4, 16, v46
    v_dot2c_f32_bf16 v20, v176, v4
    v_dot2c_f32_bf16 v21, v176, v46
    v_dot2c_f32_bf16 v28, v180, v4
    v_dot2c_f32_bf16 v29, v180, v46
    v_dot2c_f32_bf16 v22, v177, v4
    v_dot2c_f32_bf16 v23, v177, v46
    v_dot2c_f32_bf16 v30, v181, v4
    v_dot2c_f32_bf16 v31, v181, v46
    v_dot2c_f32_bf16 v24, v178, v4
    v_dot2c_f32_bf16 v25, v178, v46
    v_dot2c_f32_bf16 v32, v182, v4
    v_dot2c_f32_bf16 v33, v182, v46
    v_dot2c_f32_bf16 v26, v179, v4
    v_dot2c_f32_bf16 v27, v179, v46
    v_dot2c_f32_bf16 v34, v183, v4
    v_dot2c_f32_bf16 v35, v183, v46
    s_waitcnt vmcnt(24)
    v_lshrrev_b32 v5, 16, v47
    v_dot2c_f32_bf16 v20, v184, v5
    v_dot2c_f32_bf16 v21, v184, v47
    v_dot2c_f32_bf16 v28, v188, v5
    v_dot2c_f32_bf16 v29, v188, v47
    v_dot2c_f32_bf16 v22, v185, v5
    v_dot2c_f32_bf16 v23, v185, v47
    v_dot2c_f32_bf16 v30, v189, v5
    v_dot2c_f32_bf16 v31, v189, v47
    v_dot2c_f32_bf16 v24, v186, v5
    v_dot2c_f32_bf16 v25, v186, v47
    v_dot2c_f32_bf16 v32, v190, v5
    v_dot2c_f32_bf16 v33, v190, v47
    v_dot2c_f32_bf16 v26, v187, v5
    v_dot2c_f32_bf16 v27, v187, v47
    v_dot2c_f32_bf16 v34, v191, v5
    v_dot2c_f32_bf16 v35, v191, v47
    s_waitcnt vmcnt(22)
    v_lshrrev_b32 v4, 16, v48
    v_dot2c_f32_bf16 v20, v192, v4
    v_dot2c_f32_bf16 v21, v192, v48
    v_dot2c_f32_bf16 v28, v196, v4
    v_dot2c_f32_bf16 v29, v196, v48
    v_dot2c_f32_bf16 v22, v193, v4
    v_dot2c_f32_bf16 v23, v193, v48
    v_dot2c_f32_bf16 v30, v197, v4
    v_dot2c_f32_bf16 v31, v197, v48
    v_dot2c_f32_bf16 v24, v194, v4
    v_dot2c_f32_bf16 v25, v194, v48
    v_dot2c_f32_bf16 v32, v198, v4
    v_dot2c_f32_bf16 v33, v198, v48
    v_dot2c_f32_bf16 v26, v195, v4
    v_dot2c_f32_bf16 v27, v195, v48
    v_dot2c_f32_bf16 v34, v199, v4
    v_dot2c_f32_bf16 v35, v199, v48
    s_waitcnt vmcnt(20)
    v_lshrrev_b32 v5, 16, v49
    v_dot2c_f32_bf16 v20, v200, v5
    v_dot2c_f32_bf16 v21, v200, v49
    v_dot2c_f32_bf16 v28, v204, v5
    v_dot2c_f32_bf16 v29, v204, v49
    v_dot2c_f32_bf16 v22, v201, v5
    v_dot2c_f32_bf16 v23, v201, v49
    v_dot2c_f32_bf16 v30, v205, v5
    v_dot2c_f32_bf16 v31, v205, v49
    v_dot2c_f32_bf16 v24, v202, v5
    v_dot2c_f32_bf16 v25, v202, v49
    v_dot2c_f32_bf16 v32, v206, v5
    v_dot2c_f32_bf16 v33, v206, v49
    v_dot2c_f32_bf16 v26, v203, v5
    v_dot2c_f32_bf16 v27, v203, v49
    v_dot2c_f32_bf16 v34, v207, v5
    v_dot2c_f32_bf16 v35, v207, v49
    v_permlane32_swap_b32 v20, v28
    v_permlane32_swap_b32 v21, v29
    v_permlane32_swap_b32 v22, v30
    v_permlane32_swap_b32 v23, v31
    v_permlane32_swap_b32 v24, v32
    v_permlane32_swap_b32 v25, v33
    v_permlane32_swap_b32 v26, v34
    v_permlane32_swap_b32 v27, v35
    v_add_f32 v20, v20, v28
    v_add_f32 v21, v21, v29
    v_add_f32 v22, v22, v30
    v_add_f32 v23, v23, v31
    v_add_f32 v24, v24, v32
    v_add_f32 v25, v25, v33
    v_add_f32 v26, v26, v34
    v_add_f32 v27, v27, v35
    v_permlane16_swap_b32 v20, v24
    v_permlane16_swap_b32 v21, v25
    v_permlane16_swap_b32 v22, v26
    v_permlane16_swap_b32 v23, v27
    v_add_f32 v20, v20, v24
    v_add_f32 v21, v21, v25
    v_add_f32 v22, v22, v26
    v_add_f32 v23, v23, v27
    ds_write_b128 v71, v[20:23] offset:22784
    s_waitcnt lgkmcnt(0)
    s_barrier
    v_lshlrev_b32 v4, 5, v64
    ds_read_b128 v[20:23], v4 offset:22784
    ds_read_b128 v[24:27], v4 offset:22800
    ds_read_b128 v[28:31], v4 offset:23296
    ds_read_b128 v[32:35], v4 offset:23312
    s_waitcnt lgkmcnt(0)
    ds_read_b128 v[36:39], v4 offset:23808
    ds_read_b128 v[40:43], v4 offset:23824
    ds_read_b128 v[44:47], v4 offset:24320
    ds_read_b128 v[48:51], v4 offset:24336
    s_waitcnt lgkmcnt(0)
    v_add_f32 v20, v20, v36
    v_add_f32 v21, v21, v37
    v_add_f32 v22, v22, v38
    v_add_f32 v23, v23, v39
    v_add_f32 v24, v24, v40
    v_add_f32 v25, v25, v41
    v_add_f32 v26, v26, v42
    v_add_f32 v27, v27, v43
    v_add_f32 v28, v28, v44
    v_add_f32 v29, v29, v45
    v_add_f32 v30, v30, v46
    v_add_f32 v31, v31, v47
    v_add_f32 v32, v32, v48
    v_add_f32 v33, v33, v49
    v_add_f32 v34, v34, v50
    v_add_f32 v35, v35, v51
    ds_read_b128 v[36:39], v4 offset:24832
    ds_read_b128 v[40:43], v4 offset:24848
    ds_read_b128 v[44:47], v4 offset:25344
    ds_read_b128 v[48:51], v4 offset:25360
    s_waitcnt lgkmcnt(0)
    v_add_f32 v20, v20, v36
    v_add_f32 v21, v21, v37
    v_add_f32 v22, v22, v38
    v_add_f32 v23, v23, v39
    v_add_f32 v24, v24, v40
    v_add_f32 v25, v25, v41
    v_add_f32 v26, v26, v42
    v_add_f32 v27, v27, v43
    v_add_f32 v28, v28, v44
    v_add_f32 v29, v29, v45
    v_add_f32 v30, v30, v46
    v_add_f32 v31, v31, v47
    v_add_f32 v32, v32, v48
    v_add_f32 v33, v33, v49
    v_add_f32 v34, v34, v50
    v_add_f32 v35, v35, v51
    ds_read_b128 v[36:39], v4 offset:25856
    ds_read_b128 v[40:43], v4 offset:25872
    ds_read_b128 v[44:47], v4 offset:26368
    ds_read_b128 v[48:51], v4 offset:26384
    s_waitcnt lgkmcnt(0)
    v_add_f32 v20, v20, v36
    v_add_f32 v21, v21, v37
    v_add_f32 v22, v22, v38
    v_add_f32 v23, v23, v39
    v_add_f32 v24, v24, v40
    v_add_f32 v25, v25, v41
    v_add_f32 v26, v26, v42
    v_add_f32 v27, v27, v43
    v_add_f32 v28, v28, v44
    v_add_f32 v29, v29, v45
    v_add_f32 v30, v30, v46
    v_add_f32 v31, v31, v47
    v_add_f32 v32, v32, v48
    v_add_f32 v33, v33, v49
    v_add_f32 v34, v34, v50
    v_add_f32 v35, v35, v51
    ds_read_b128 v[36:39], v4 offset:26880
    ds_read_b128 v[40:43], v4 offset:26896
    ds_read_b128 v[44:47], v4 offset:27392
    ds_read_b128 v[48:51], v4 offset:27408
    s_waitcnt lgkmcnt(0)
    v_add_f32 v20, v20, v36
    v_add_f32 v21, v21, v37
    v_add_f32 v22, v22, v38
    v_add_f32 v23, v23, v39
    v_add_f32 v24, v24, v40
    v_add_f32 v25, v25, v41
    v_add_f32 v26, v26, v42
    v_add_f32 v27, v27, v43
    v_add_f32 v28, v28, v44
    v_add_f32 v29, v29, v45
    v_add_f32 v30, v30, v46
    v_add_f32 v31, v31, v47
    v_add_f32 v32, v32, v48
    v_add_f32 v33, v33, v49
    v_add_f32 v34, v34, v50
    v_add_f32 v35, v35, v51
    ds_read_b128 v[36:39], v4 offset:27904
    ds_read_b128 v[40:43], v4 offset:27920
    ds_read_b128 v[44:47], v4 offset:28416
    ds_read_b128 v[48:51], v4 offset:28432
    s_waitcnt lgkmcnt(0)
    v_add_f32 v20, v20, v36
    v_add_f32 v21, v21, v37
    v_add_f32 v22, v22, v38
    v_add_f32 v23, v23, v39
    v_add_f32 v24, v24, v40
    v_add_f32 v25, v25, v41
    v_add_f32 v26, v26, v42
    v_add_f32 v27, v27, v43
    v_add_f32 v28, v28, v44
    v_add_f32 v29, v29, v45
    v_add_f32 v30, v30, v46
    v_add_f32 v31, v31, v47
    v_add_f32 v32, v32, v48
    v_add_f32 v33, v33, v49
    v_add_f32 v34, v34, v50
    v_add_f32 v35, v35, v51
    ds_read_b128 v[36:39], v4 offset:28928
    ds_read_b128 v[40:43], v4 offset:28944
    ds_read_b128 v[44:47], v4 offset:29440
    ds_read_b128 v[48:51], v4 offset:29456
    s_waitcnt lgkmcnt(0)
    v_add_f32 v20, v20, v36
    v_add_f32 v21, v21, v37
    v_add_f32 v22, v22, v38
    v_add_f32 v23, v23, v39
    v_add_f32 v24, v24, v40
    v_add_f32 v25, v25, v41
    v_add_f32 v26, v26, v42
    v_add_f32 v27, v27, v43
    v_add_f32 v28, v28, v44
    v_add_f32 v29, v29, v45
    v_add_f32 v30, v30, v46
    v_add_f32 v31, v31, v47
    v_add_f32 v32, v32, v48
    v_add_f32 v33, v33, v49
    v_add_f32 v34, v34, v50
    v_add_f32 v35, v35, v51
    ds_read_b128 v[36:39], v4 offset:29952
    ds_read_b128 v[40:43], v4 offset:29968
    ds_read_b128 v[44:47], v4 offset:30464
    ds_read_b128 v[48:51], v4 offset:30480
    s_waitcnt lgkmcnt(0)
    v_add_f32 v20, v20, v36
    v_add_f32 v21, v21, v37
    v_add_f32 v22, v22, v38
    v_add_f32 v23, v23, v39
    v_add_f32 v24, v24, v40
    v_add_f32 v25, v25, v41
    v_add_f32 v26, v26, v42
    v_add_f32 v27, v27, v43
    v_add_f32 v28, v28, v44
    v_add_f32 v29, v29, v45
    v_add_f32 v30, v30, v46
    v_add_f32 v31, v31, v47
    v_add_f32 v32, v32, v48
    v_add_f32 v33, v33, v49
    v_add_f32 v34, v34, v50
    v_add_f32 v35, v35, v51
    v_cvt_pk_bf16_f32 v12, v20, v21
    v_cvt_pk_bf16_f32 v13, v22, v23
    v_cvt_pk_bf16_f32 v14, v24, v25
    v_cvt_pk_bf16_f32 v15, v26, v27
    v_cvt_pk_bf16_f32 v16, v28, v29
    v_cvt_pk_bf16_f32 v17, v30, v31
    v_cvt_pk_bf16_f32 v18, v32, v33
    v_cvt_pk_bf16_f32 v19, v34, v35
    s_cmp_lg_u32 s4, 3
    s_cbranch_scc1 K1_NOPUB
    s_cmp_ge_u32 s2, 224
    s_cbranch_scc1 K1_NOPUB
    ds_read_b128 v[20:23], v65 offset:39168
    s_waitcnt lgkmcnt(0)
    ds_read_b128 v[36:39], v65 offset:40192
    s_waitcnt lgkmcnt(0)
    v_add_f32 v20, v20, v36
    v_add_f32 v21, v21, v37
    v_add_f32 v22, v22, v38
    v_add_f32 v23, v23, v39
    ds_read_b128 v[36:39], v65 offset:41216
    s_waitcnt lgkmcnt(0)
    v_add_f32 v20, v20, v36
    v_add_f32 v21, v21, v37
    v_add_f32 v22, v22, v38
    v_add_f32 v23, v23, v39
    ds_read_b128 v[36:39], v65 offset:42240
    s_waitcnt lgkmcnt(0)
    v_add_f32 v20, v20, v36
    v_add_f32 v21, v21, v37
    v_add_f32 v22, v22, v38
    v_add_f32 v23, v23, v39
    ds_read_b128 v[36:39], v65 offset:43264
    s_waitcnt lgkmcnt(0)
    v_add_f32 v20, v20, v36
    v_add_f32 v21, v21, v37
    v_add_f32 v22, v22, v38
    v_add_f32 v23, v23, v39
    ds_read_b128 v[36:39], v65 offset:44288
    s_waitcnt lgkmcnt(0)
    v_add_f32 v20, v20, v36
    v_add_f32 v21, v21, v37
    v_add_f32 v22, v22, v38
    v_add_f32 v23, v23, v39
    ds_read_b128 v[36:39], v65 offset:45312
    s_waitcnt lgkmcnt(0)
    v_add_f32 v20, v20, v36
    v_add_f32 v21, v21, v37
    v_add_f32 v22, v22, v38
    v_add_f32 v23, v23, v39
    s_lshl_b32 s15, s88, 3
    s_add_u32 s15, s15, s89
    s_lshl_b32 s15, s15, 10
    s_add_u32 s15, s15, 2392064
    buffer_store_dwordx4 v[20:23], v65, s[72:75], s15 offen sc0 sc1
    s_waitcnt vmcnt(0)
    s_lshl_b32 s15, s88, 2
    s_add_u32 s15, s15, 64
    v_mov_b32 v5, s15
    v_mov_b32 v6, 1
    s_mov_b64 exec, 1
    buffer_atomic_add v6, v5, s[84:87], 0 offen sc1
    s_waitcnt vmcnt(0)
    s_mov_b64 exec, -1
K1_NOPUB:
    s_nop 3
    v_mov_b32 v20, 0
    v_mov_b32 v21, 0
    v_mov_b32 v22, 0
    v_mov_b32 v23, 0
    v_mov_b32 v24, 0
    v_mov_b32 v25, 0
    v_mov_b32 v26, 0
    v_mov_b32 v27, 0
    v_mov_b32 v28, 0
    v_mov_b32 v29, 0
    v_mov_b32 v30, 0
    v_mov_b32 v31, 0
    v_mov_b32 v32, 0
    v_mov_b32 v33, 0
    v_mov_b32 v34, 0
    v_mov_b32 v35, 0
    v_mov_b32 v61, 0
    v_mov_b32 v36, 0
    v_mov_b32 v37, 0
    v_mov_b32 v38, 0
    v_mov_b32 v39, 0
    v_mov_b32 v40, 0
    v_mov_b32 v41, 0
    v_mov_b32 v42, 0
    v_mov_b32 v43, 0
    v_dot2c_f32_bf16 v36, v88, v12
    v_dot2c_f32_bf16 v36, v89, v13
    v_dot2c_f32_bf16 v36, v90, v14
    v_dot2c_f32_bf16 v36, v91, v15
    v_dot2c_f32_bf16 v36, v92, v16
    v_dot2c_f32_bf16 v36, v93, v17
    v_dot2c_f32_bf16 v36, v94, v18
    v_dot2c_f32_bf16 v36, v95, v19
    s_mov_b32 s3, 8192
    buffer_load_dwordx4 v[128:131], v1, s[48:51], s3 offen nt
    v_dot2c_f32_bf16 v37, v96, v12
    v_dot2c_f32_bf16 v37, v97, v13
    v_dot2c_f32_bf16 v37, v98, v14
    v_dot2c_f32_bf16 v37, v99, v15
    v_dot2c_f32_bf16 v37, v100, v16
    v_dot2c_f32_bf16 v37, v101, v17
    v_dot2c_f32_bf16 v37, v102, v18
    v_dot2c_f32_bf16 v37, v103, v19
    s_waitcnt vmcnt(19)
    v_dot2c_f32_bf16 v38, v208, v12
    v_dot2c_f32_bf16 v38, v209, v13
    v_dot2c_f32_bf16 v38, v210, v14
    v_dot2c_f32_bf16 v38, v211, v15
    v_dot2c_f32_bf16 v38, v212, v16
    v_dot2c_f32_bf16 v38, v213, v17
    v_dot2c_f32_bf16 v38, v214, v18
    v_dot2c_f32_bf16 v38, v215, v19
    s_waitcnt vmcnt(17)
    v_dot2c_f32_bf16 v39, v216, v12
    v_dot2c_f32_bf16 v39, v217, v13
    v_dot2c_f32_bf16 v39, v218, v14
    v_dot2c_f32_bf16 v39, v219, v15
    v_dot2c_f32_bf16 v39, v220, v16
    v_dot2c_f32_bf16 v39, v221, v17
    v_dot2c_f32_bf16 v39, v222, v18
    v_dot2c_f32_bf16 v39, v223, v19
    s_waitcnt vmcnt(15)
    v_dot2c_f32_bf16 v40, v224, v12
    v_dot2c_f32_bf16 v40, v225, v13
    v_dot2c_f32_bf16 v40, v226, v14
    v_dot2c_f32_bf16 v40, v227, v15
    v_dot2c_f32_bf16 v40, v228, v16
    v_dot2c_f32_bf16 v40, v229, v17
    v_dot2c_f32_bf16 v40, v230, v18
    v_dot2c_f32_bf16 v40, v231, v19
    s_waitcnt vmcnt(13)
    v_dot2c_f32_bf16 v41, v232, v12
    v_dot2c_f32_bf16 v41, v233, v13
    v_dot2c_f32_bf16 v41, v234, v14
    v_dot2c_f32_bf16 v41, v235, v15
    v_dot2c_f32_bf16 v41, v236, v16
    v_dot2c_f32_bf16 v41, v237, v17
    v_dot2c_f32_bf16 v41, v238, v18
    v_dot2c_f32_bf16 v41, v239, v19
    s_waitcnt vmcnt(11)
    v_dot2c_f32_bf16 v42, v240, v12
    v_dot2c_f32_bf16 v42, v241, v13
    v_dot2c_f32_bf16 v42, v242, v14
    v_dot2c_f32_bf16 v42, v243, v15
    v_dot2c_f32_bf16 v42, v244, v16
    v_dot2c_f32_bf16 v42, v245, v17
    v_dot2c_f32_bf16 v42, v246, v18
    v_dot2c_f32_bf16 v42, v247, v19
    buffer_load_dwordx4 v[132:135], v1, s[48:51], s3 offen offset:256 nt
    s_waitcnt vmcnt(10)
    v_dot2c_f32_bf16 v43, v252, v12
    v_dot2c_f32_bf16 v43, v253, v13
    v_dot2c_f32_bf16 v43, v254, v14
    v_dot2c_f32_bf16 v43, v255, v15
    v_dot2c_f32_bf16 v43, v248, v16
    v_dot2c_f32_bf16 v43, v249, v17
    v_dot2c_f32_bf16 v43, v250, v18
    v_dot2c_f32_bf16 v43, v251, v19
    buffer_load_dwordx4 v[136:139], v1, s[48:51], s3 offen offset:2048 nt
    buffer_load_dwordx4 v[140:143], v1, s[48:51], s3 offen offset:2304 nt
    v_add_f32_dpp v36, v36, v36 quad_perm:[1,0,3,2] row_mask:0xf bank_mask:0xf
    v_add_f32_dpp v37, v37, v37 quad_perm:[1,0,3,2] row_mask:0xf bank_mask:0xf
    v_add_f32_dpp v38, v38, v38 quad_perm:[1,0,3,2] row_mask:0xf bank_mask:0xf
    v_add_f32_dpp v39, v39, v39 quad_perm:[1,0,3,2] row_mask:0xf bank_mask:0xf
    v_add_f32_dpp v40, v40, v40 quad_perm:[1,0,3,2] row_mask:0xf bank_mask:0xf
    v_add_f32_dpp v41, v41, v41 quad_perm:[1,0,3,2] row_mask:0xf bank_mask:0xf
    v_add_f32_dpp v42, v42, v42 quad_perm:[1,0,3,2] row_mask:0xf bank_mask:0xf
    v_add_f32_dpp v43, v43, v43 quad_perm:[1,0,3,2] row_mask:0xf bank_mask:0xf
    v_add_f32_dpp v36, v36, v36 quad_perm:[2,3,0,1] row_mask:0xf bank_mask:0xf
    v_add_f32_dpp v37, v37, v37 quad_perm:[2,3,0,1] row_mask:0xf bank_mask:0xf
    v_add_f32_dpp v38, v38, v38 quad_perm:[2,3,0,1] row_mask:0xf bank_mask:0xf
    v_add_f32_dpp v39, v39, v39 quad_perm:[2,3,0,1] row_mask:0xf bank_mask:0xf
    v_add_f32_dpp v40, v40, v40 quad_perm:[2,3,0,1] row_mask:0xf bank_mask:0xf
    v_add_f32_dpp v41, v41, v41 quad_perm:[2,3,0,1] row_mask:0xf bank_mask:0xf
    v_add_f32_dpp v42, v42, v42 quad_perm:[2,3,0,1] row_mask:0xf bank_mask:0xf
    v_add_f32_dpp v43, v43, v43 quad_perm:[2,3,0,1] row_mask:0xf bank_mask:0xf
    v_add_f32_dpp v36, v36, v36 row_half_mirror row_mask:0xf bank_mask:0xf
    v_add_f32_dpp v37, v37, v37 row_half_mirror row_mask:0xf bank_mask:0xf
    v_add_f32_dpp v38, v38, v38 row_half_mirror row_mask:0xf bank_mask:0xf
    v_add_f32_dpp v39, v39, v39 row_half_mirror row_mask:0xf bank_mask:0xf
    v_add_f32_dpp v40, v40, v40 row_half_mirror row_mask:0xf bank_mask:0xf
    v_add_f32_dpp v41, v41, v41 row_half_mirror row_mask:0xf bank_mask:0xf
    v_add_f32_dpp v42, v42, v42 row_half_mirror row_mask:0xf bank_mask:0xf
    v_add_f32_dpp v43, v43, v43 row_half_mirror row_mask:0xf bank_mask:0xf
    v_add_f32_dpp v36, v36, v36 row_mirror row_mask:0xf bank_mask:0xf
    v_add_f32_dpp v37, v37, v37 row_mirror row_mask:0xf bank_mask:0xf
    v_add_f32_dpp v38, v38, v38 row_mirror row_mask:0xf bank_mask:0xf
    v_add_f32_dpp v39, v39, v39 row_mirror row_mask:0xf bank_mask:0xf
    v_add_f32_dpp v40, v40, v40 row_mirror row_mask:0xf bank_mask:0xf
    v_add_f32_dpp v41, v41, v41 row_mirror row_mask:0xf bank_mask:0xf
    v_add_f32_dpp v42, v42, v42 row_mirror row_mask:0xf bank_mask:0xf
    v_add_f32_dpp v43, v43, v43 row_mirror row_mask:0xf bank_mask:0xf
    v_cvt_pk_bf16_f32 v36, 0, v36
    v_cvt_pk_bf16_f32 v37, 0, v37
    v_cvt_pk_bf16_f32 v38, 0, v38
    v_cvt_pk_bf16_f32 v39, 0, v39
    v_cvt_pk_bf16_f32 v40, 0, v40
    v_cvt_pk_bf16_f32 v41, 0, v41
    v_cvt_pk_bf16_f32 v42, 0, v42
    v_cvt_pk_bf16_f32 v43, 0, v43
    v_max3_f32 v4, v36, v37, v38
    v_max3_f32 v4, v4, v39, v40
    v_max3_f32 v4, v4, v41, v42
    v_max_f32 v4, v4, v43
    v_mov_b32 v60, v4
    v_mul_f32 v6, s14, v60
    v_fma_f32 v36, v36, s14, -v6
    v_fma_f32 v37, v37, s14, -v6
    v_fma_f32 v38, v38, s14, -v6
    v_fma_f32 v39, v39, s14, -v6
    v_fma_f32 v40, v40, s14, -v6
    v_fma_f32 v41, v41, s14, -v6
    v_fma_f32 v42, v42, s14, -v6
    v_fma_f32 v43, v43, s14, -v6
    v_exp_f32 v36, v36
    v_exp_f32 v37, v37
    v_exp_f32 v38, v38
    v_exp_f32 v39, v39
    v_exp_f32 v40, v40
    v_exp_f32 v41, v41
    v_exp_f32 v42, v42
    v_exp_f32 v43, v43
    v_cvt_pk_bf16_f32 v45, 0, v36
    v_cvt_pk_bf16_f32 v44, v36, 0
    v_cvt_pk_bf16_f32 v47, 0, v37
    v_cvt_pk_bf16_f32 v46, v37, 0
    v_cvt_pk_bf16_f32 v49, 0, v38
    v_cvt_pk_bf16_f32 v48, v38, 0
    v_cvt_pk_bf16_f32 v51, 0, v39
    v_cvt_pk_bf16_f32 v50, v39, 0
    v_cvt_pk_bf16_f32 v53, 0, v40
    v_cvt_pk_bf16_f32 v52, v40, 0
    v_cvt_pk_bf16_f32 v55, 0, v41
    v_cvt_pk_bf16_f32 v54, v41, 0
    v_cvt_pk_bf16_f32 v57, 0, v42
    v_cvt_pk_bf16_f32 v56, v42, 0
    v_cvt_pk_bf16_f32 v59, 0, v43
    v_cvt_pk_bf16_f32 v58, v43, 0
    v_add_f32 v61, v61, v45
    v_add_f32 v61, v61, v47
    v_add_f32 v61, v61, v49
    v_add_f32 v61, v61, v51
    v_add_f32 v61, v61, v53
    v_add_f32 v61, v61, v55
    v_add_f32 v61, v61, v57
    v_add_f32 v61, v61, v59
    s_waitcnt vmcnt(10)
    v_dot2c_f32_bf16 v20, v80, v44
    v_dot2c_f32_bf16 v21, v80, v45
    v_dot2c_f32_bf16 v28, v84, v44
    v_dot2c_f32_bf16 v29, v84, v45
    v_dot2c_f32_bf16 v22, v81, v44
    v_dot2c_f32_bf16 v23, v81, v45
    v_dot2c_f32_bf16 v30, v85, v44
    v_dot2c_f32_bf16 v31, v85, v45
    v_dot2c_f32_bf16 v24, v82, v44
    v_dot2c_f32_bf16 v25, v82, v45
    v_dot2c_f32_bf16 v32, v86, v44
    v_dot2c_f32_bf16 v33, v86, v45
    v_dot2c_f32_bf16 v26, v83, v44
    v_dot2c_f32_bf16 v27, v83, v45
    v_dot2c_f32_bf16 v34, v87, v44
    v_dot2c_f32_bf16 v35, v87, v45
    s_mov_b32 s3, 12288
    buffer_load_dwordx4 v[144:147], v1, s[48:51], s3 offen nt
    buffer_load_dwordx4 v[148:151], v1, s[48:51], s3 offen offset:256 nt
    s_waitcnt vmcnt(10)
    v_dot2c_f32_bf16 v20, v104, v46
    v_dot2c_f32_bf16 v21, v104, v47
    v_dot2c_f32_bf16 v28, v108, v46
    v_dot2c_f32_bf16 v29, v108, v47
    v_dot2c_f32_bf16 v22, v105, v46
    v_dot2c_f32_bf16 v23, v105, v47
    v_dot2c_f32_bf16 v30, v109, v46
    v_dot2c_f32_bf16 v31, v109, v47
    v_dot2c_f32_bf16 v24, v106, v46
    v_dot2c_f32_bf16 v25, v106, v47
    v_dot2c_f32_bf16 v32, v110, v46
    v_dot2c_f32_bf16 v33, v110, v47
    v_dot2c_f32_bf16 v26, v107, v46
    v_dot2c_f32_bf16 v27, v107, v47
    v_dot2c_f32_bf16 v34, v111, v46
    v_dot2c_f32_bf16 v35, v111, v47
    buffer_load_dwordx4 v[152:155], v1, s[48:51], s3 offen offset:2048 nt
    buffer_load_dwordx4 v[156:159], v1, s[48:51], s3 offen offset:2304 nt
    s_waitcnt vmcnt(10)
    v_dot2c_f32_bf16 v20, v112, v48
    v_dot2c_f32_bf16 v21, v112, v49
    v_dot2c_f32_bf16 v28, v116, v48
    v_dot2c_f32_bf16 v29, v116, v49
    v_dot2c_f32_bf16 v22, v113, v48
    v_dot2c_f32_bf16 v23, v113, v49
    v_dot2c_f32_bf16 v30, v117, v48
    v_dot2c_f32_bf16 v31, v117, v49
    v_dot2c_f32_bf16 v24, v114, v48
    v_dot2c_f32_bf16 v25, v114, v49
    v_dot2c_f32_bf16 v32, v118, v48
    v_dot2c_f32_bf16 v33, v118, v49
    v_dot2c_f32_bf16 v26, v115, v48
    v_dot2c_f32_bf16 v27, v115, v49
    v_dot2c_f32_bf16 v34, v119, v48
    v_dot2c_f32_bf16 v35, v119, v49
    s_mov_b32 s3, 16384
    buffer_load_dwordx4 v[160:163], v1, s[44:47], s3 offen nt
    buffer_load_dwordx4 v[164:167], v1, s[44:47], s3 offen offset:256 nt
    s_waitcnt vmcnt(10)
    v_dot2c_f32_bf16 v20, v120, v50
    v_dot2c_f32_bf16 v21, v120, v51
    v_dot2c_f32_bf16 v28, v124, v50
    v_dot2c_f32_bf16 v29, v124, v51
    v_dot2c_f32_bf16 v22, v121, v50
    v_dot2c_f32_bf16 v23, v121, v51
    v_dot2c_f32_bf16 v30, v125, v50
    v_dot2c_f32_bf16 v31, v125, v51
    v_dot2c_f32_bf16 v24, v122, v50
    v_dot2c_f32_bf16 v25, v122, v51
    v_dot2c_f32_bf16 v32, v126, v50
    v_dot2c_f32_bf16 v33, v126, v51
    v_dot2c_f32_bf16 v26, v123, v50
    v_dot2c_f32_bf16 v27, v123, v51
    v_dot2c_f32_bf16 v34, v127, v50
    v_dot2c_f32_bf16 v35, v127, v51
    buffer_load_dwordx4 v[168:171], v1, s[44:47], s3 offen offset:2048 nt
    buffer_load_dwordx4 v[172:175], v1, s[44:47], s3 offen offset:2304 nt
    s_waitcnt vmcnt(10)
    v_dot2c_f32_bf16 v20, v128, v52
    v_dot2c_f32_bf16 v21, v128, v53
    v_dot2c_f32_bf16 v28, v132, v52
    v_dot2c_f32_bf16 v29, v132, v53
    v_dot2c_f32_bf16 v22, v129, v52
    v_dot2c_f32_bf16 v23, v129, v53
    v_dot2c_f32_bf16 v30, v133, v52
    v_dot2c_f32_bf16 v31, v133, v53
    v_dot2c_f32_bf16 v24, v130, v52
    v_dot2c_f32_bf16 v25, v130, v53
    v_dot2c_f32_bf16 v32, v134, v52
    v_dot2c_f32_bf16 v33, v134, v53
    v_dot2c_f32_bf16 v26, v131, v52
    v_dot2c_f32_bf16 v27, v131, v53
    v_dot2c_f32_bf16 v34, v135, v52
    v_dot2c_f32_bf16 v35, v135, v53
    s_mov_b32 s3, 20480
    buffer_load_dwordx4 v[176:179], v1, s[44:47], s3 offen nt
    buffer_load_dwordx4 v[180:183], v1, s[44:47], s3 offen offset:256 nt
    s_waitcnt vmcnt(10)
    v_dot2c_f32_bf16 v20, v136, v54
    v_dot2c_f32_bf16 v21, v136, v55
    v_dot2c_f32_bf16 v28, v140, v54
    v_dot2c_f32_bf16 v29, v140, v55
    v_dot2c_f32_bf16 v22, v137, v54
    v_dot2c_f32_bf16 v23, v137, v55
    v_dot2c_f32_bf16 v30, v141, v54
    v_dot2c_f32_bf16 v31, v141, v55
    v_dot2c_f32_bf16 v24, v138, v54
    v_dot2c_f32_bf16 v25, v138, v55
    v_dot2c_f32_bf16 v32, v142, v54
    v_dot2c_f32_bf16 v33, v142, v55
    v_dot2c_f32_bf16 v26, v139, v54
    v_dot2c_f32_bf16 v27, v139, v55
    v_dot2c_f32_bf16 v34, v143, v54
    v_dot2c_f32_bf16 v35, v143, v55
    buffer_load_dwordx4 v[184:187], v1, s[44:47], s3 offen offset:2048 nt
    buffer_load_dwordx4 v[188:191], v1, s[44:47], s3 offen offset:2304 nt
    s_waitcnt vmcnt(10)
    v_dot2c_f32_bf16 v20, v144, v56
    v_dot2c_f32_bf16 v21, v144, v57
    v_dot2c_f32_bf16 v28, v148, v56
    v_dot2c_f32_bf16 v29, v148, v57
    v_dot2c_f32_bf16 v22, v145, v56
    v_dot2c_f32_bf16 v23, v145, v57
    v_dot2c_f32_bf16 v30, v149, v56
    v_dot2c_f32_bf16 v31, v149, v57
    v_dot2c_f32_bf16 v24, v146, v56
    v_dot2c_f32_bf16 v25, v146, v57
    v_dot2c_f32_bf16 v32, v150, v56
    v_dot2c_f32_bf16 v33, v150, v57
    v_dot2c_f32_bf16 v26, v147, v56
    v_dot2c_f32_bf16 v27, v147, v57
    v_dot2c_f32_bf16 v34, v151, v56
    v_dot2c_f32_bf16 v35, v151, v57
    s_mov_b32 s3, 24576
    buffer_load_dwordx4 v[192:195], v1, s[44:47], s3 offen nt
    buffer_load_dwordx4 v[196:199], v1, s[44:47], s3 offen offset:256 nt
    s_waitcnt vmcnt(10)
    v_dot2c_f32_bf16 v20, v152, v58
    v_dot2c_f32_bf16 v21, v152, v59
    v_dot2c_f32_bf16 v28, v156, v58
    v_dot2c_f32_bf16 v29, v156, v59
    v_dot2c_f32_bf16 v22, v153, v58
    v_dot2c_f32_bf16 v23, v153, v59
    v_dot2c_f32_bf16 v30, v157, v58
    v_dot2c_f32_bf16 v31, v157, v59
    v_dot2c_f32_bf16 v24, v154, v58
    v_dot2c_f32_bf16 v25, v154, v59
    v_dot2c_f32_bf16 v32, v158, v58
    v_dot2c_f32_bf16 v33, v158, v59
    v_dot2c_f32_bf16 v26, v155, v58
    v_dot2c_f32_bf16 v27, v155, v59
    v_dot2c_f32_bf16 v34, v159, v58
    v_dot2c_f32_bf16 v35, v159, v59
    buffer_load_dwordx4 v[200:203], v1, s[44:47], s3 offen offset:2048 nt
    buffer_load_dwordx4 v[204:207], v1, s[44:47], s3 offen offset:2304 nt
    v_mov_b32 v36, 0
    v_mov_b32 v37, 0
    v_mov_b32 v38, 0
    v_mov_b32 v39, 0
    v_mov_b32 v40, 0
    v_mov_b32 v41, 0
    v_mov_b32 v42, 0
    v_mov_b32 v43, 0
    s_waitcnt vmcnt(10)
    v_dot2c_f32_bf16 v36, v160, v12
    v_dot2c_f32_bf16 v36, v161, v13
    v_dot2c_f32_bf16 v36, v162, v14
    v_dot2c_f32_bf16 v36, v163, v15
    v_dot2c_f32_bf16 v36, v164, v16
    v_dot2c_f32_bf16 v36, v165, v17
    v_dot2c_f32_bf16 v36, v166, v18
    v_dot2c_f32_bf16 v36, v167, v19
    s_mov_b32 s3, 28672
    buffer_load_dwordx4 v[88:91], v1, s[44:47], s3 offen nt
    buffer_load_dwordx4 v[92:95], v1, s[44:47], s3 offen offset:256 nt
    buffer_load_dwordx4 v[96:99], v3, s[56:59], 0 offen
    buffer_load_dwordx4 v[100:103], v3, s[56:59], 0 offen offset:896
    s_waitcnt vmcnt(12)
    v_dot2c_f32_bf16 v37, v168, v12
    v_dot2c_f32_bf16 v37, v169, v13
    v_dot2c_f32_bf16 v37, v170, v14
    v_dot2c_f32_bf16 v37, v171, v15
    v_dot2c_f32_bf16 v37, v172, v16
    v_dot2c_f32_bf16 v37, v173, v17
    v_dot2c_f32_bf16 v37, v174, v18
    v_dot2c_f32_bf16 v37, v175, v19
    buffer_load_dwordx4 v[208:211], v1, s[44:47], s3 offen offset:2048 nt
    buffer_load_dwordx4 v[212:215], v1, s[44:47], s3 offen offset:2304 nt
    buffer_load_dwordx4 v[216:219], v3, s[56:59], 0 offen offset:1792
    buffer_load_dwordx4 v[220:223], v3, s[56:59], 0 offen offset:2688
    s_waitcnt vmcnt(14)
    v_dot2c_f32_bf16 v38, v176, v12
    v_dot2c_f32_bf16 v38, v177, v13
    v_dot2c_f32_bf16 v38, v178, v14
    v_dot2c_f32_bf16 v38, v179, v15
    v_dot2c_f32_bf16 v38, v180, v16
    v_dot2c_f32_bf16 v38, v181, v17
    v_dot2c_f32_bf16 v38, v182, v18
    v_dot2c_f32_bf16 v38, v183, v19
    s_mov_b32 s3, 16384
    buffer_load_dwordx4 v[224:227], v1, s[48:51], s3 offen nt
    buffer_load_dwordx4 v[228:231], v1, s[48:51], s3 offen offset:256 nt
    s_mov_b32 s3, 3584
    buffer_load_dwordx4 v[232:235], v3, s[56:59], s3 offen
    buffer_load_dwordx4 v[236:239], v3, s[56:59], s3 offen offset:896
    s_waitcnt vmcnt(16)
    v_dot2c_f32_bf16 v39, v184, v12
    v_dot2c_f32_bf16 v39, v185, v13
    v_dot2c_f32_bf16 v39, v186, v14
    v_dot2c_f32_bf16 v39, v187, v15
    v_dot2c_f32_bf16 v39, v188, v16
    v_dot2c_f32_bf16 v39, v189, v17
    v_dot2c_f32_bf16 v39, v190, v18
    v_dot2c_f32_bf16 v39, v191, v19
    s_mov_b32 s3, 16384
    buffer_load_dwordx4 v[240:243], v1, s[48:51], s3 offen offset:2048 nt
    buffer_load_dwordx4 v[244:247], v1, s[48:51], s3 offen offset:2304 nt
    s_mov_b32 s3, 3584
    buffer_load_dwordx4 v[252:255], v3, s[56:59], s3 offen offset:1792
    buffer_load_dwordx4 v[248:251], v3, s[56:59], s3 offen offset:2688
    s_waitcnt vmcnt(18)
    v_dot2c_f32_bf16 v40, v192, v12
    v_dot2c_f32_bf16 v40, v193, v13
    v_dot2c_f32_bf16 v40, v194, v14
    v_dot2c_f32_bf16 v40, v195, v15
    v_dot2c_f32_bf16 v40, v196, v16
    v_dot2c_f32_bf16 v40, v197, v17
    v_dot2c_f32_bf16 v40, v198, v18
    v_dot2c_f32_bf16 v40, v199, v19
    s_mov_b32 s3, 20480
    buffer_load_dwordx4 v[80:83], v1, s[48:51], s3 offen nt
    buffer_load_dwordx4 v[84:87], v1, s[48:51], s3 offen offset:256 nt
    s_mov_b32 s3, 7168
    buffer_load_dwordx4 v[104:107], v3, s[56:59], s3 offen
    buffer_load_dwordx4 v[108:111], v3, s[56:59], s3 offen offset:896
    s_waitcnt vmcnt(20)
    v_dot2c_f32_bf16 v41, v200, v12
    v_dot2c_f32_bf16 v41, v201, v13
    v_dot2c_f32_bf16 v41, v202, v14
    v_dot2c_f32_bf16 v41, v203, v15
    v_dot2c_f32_bf16 v41, v204, v16
    v_dot2c_f32_bf16 v41, v205, v17
    v_dot2c_f32_bf16 v41, v206, v18
    v_dot2c_f32_bf16 v41, v207, v19
    s_mov_b32 s3, 20480
    buffer_load_dwordx4 v[112:115], v1, s[48:51], s3 offen offset:2048 nt
    buffer_load_dwordx4 v[116:119], v1, s[48:51], s3 offen offset:2304 nt
    s_mov_b32 s3, 7168
    buffer_load_dwordx4 v[120:123], v3, s[56:59], s3 offen offset:1792
    buffer_load_dwordx4 v[124:127], v3, s[56:59], s3 offen offset:2688
    s_waitcnt vmcnt(22)
    v_dot2c_f32_bf16 v42, v88, v12
    v_dot2c_f32_bf16 v42, v89, v13
    v_dot2c_f32_bf16 v42, v90, v14
    v_dot2c_f32_bf16 v42, v91, v15
    v_dot2c_f32_bf16 v42, v92, v16
    v_dot2c_f32_bf16 v42, v93, v17
    v_dot2c_f32_bf16 v42, v94, v18
    v_dot2c_f32_bf16 v42, v95, v19
    s_mov_b32 s3, 24576
    buffer_load_dwordx4 v[128:131], v1, s[48:51], s3 offen nt
    buffer_load_dwordx4 v[132:135], v1, s[48:51], s3 offen offset:256 nt
    s_mov_b32 s3, 10752
    buffer_load_dwordx4 v[136:139], v3, s[56:59], s3 offen
    buffer_load_dwordx4 v[140:143], v3, s[56:59], s3 offen offset:896
    s_waitcnt vmcnt(22)
    v_dot2c_f32_bf16 v43, v208, v12
    v_dot2c_f32_bf16 v43, v209, v13
    v_dot2c_f32_bf16 v43, v210, v14
    v_dot2c_f32_bf16 v43, v211, v15
    v_dot2c_f32_bf16 v43, v212, v16
    v_dot2c_f32_bf16 v43, v213, v17
    v_dot2c_f32_bf16 v43, v214, v18
    v_dot2c_f32_bf16 v43, v215, v19
    s_mov_b32 s3, 24576
    buffer_load_dwordx4 v[144:147], v1, s[48:51], s3 offen offset:2048 nt
    buffer_load_dwordx4 v[148:151], v1, s[48:51], s3 offen offset:2304 nt
    s_mov_b32 s3, 10752
    buffer_load_dwordx4 v[152:155], v3, s[56:59], s3 offen offset:1792
    buffer_load_dwordx4 v[156:159], v3, s[56:59], s3 offen offset:2688
    v_add_f32_dpp v36, v36, v36 quad_perm:[1,0,3,2] row_mask:0xf bank_mask:0xf
    v_add_f32_dpp v37, v37, v37 quad_perm:[1,0,3,2] row_mask:0xf bank_mask:0xf
    v_add_f32_dpp v38, v38, v38 quad_perm:[1,0,3,2] row_mask:0xf bank_mask:0xf
    v_add_f32_dpp v39, v39, v39 quad_perm:[1,0,3,2] row_mask:0xf bank_mask:0xf
    v_add_f32_dpp v40, v40, v40 quad_perm:[1,0,3,2] row_mask:0xf bank_mask:0xf
    v_add_f32_dpp v41, v41, v41 quad_perm:[1,0,3,2] row_mask:0xf bank_mask:0xf
    v_add_f32_dpp v42, v42, v42 quad_perm:[1,0,3,2] row_mask:0xf bank_mask:0xf
    v_add_f32_dpp v43, v43, v43 quad_perm:[1,0,3,2] row_mask:0xf bank_mask:0xf
    v_add_f32_dpp v36, v36, v36 quad_perm:[2,3,0,1] row_mask:0xf bank_mask:0xf
    v_add_f32_dpp v37, v37, v37 quad_perm:[2,3,0,1] row_mask:0xf bank_mask:0xf
    v_add_f32_dpp v38, v38, v38 quad_perm:[2,3,0,1] row_mask:0xf bank_mask:0xf
    v_add_f32_dpp v39, v39, v39 quad_perm:[2,3,0,1] row_mask:0xf bank_mask:0xf
    v_add_f32_dpp v40, v40, v40 quad_perm:[2,3,0,1] row_mask:0xf bank_mask:0xf
    v_add_f32_dpp v41, v41, v41 quad_perm:[2,3,0,1] row_mask:0xf bank_mask:0xf
    v_add_f32_dpp v42, v42, v42 quad_perm:[2,3,0,1] row_mask:0xf bank_mask:0xf
    v_add_f32_dpp v43, v43, v43 quad_perm:[2,3,0,1] row_mask:0xf bank_mask:0xf
    v_add_f32_dpp v36, v36, v36 row_half_mirror row_mask:0xf bank_mask:0xf
    v_add_f32_dpp v37, v37, v37 row_half_mirror row_mask:0xf bank_mask:0xf
    v_add_f32_dpp v38, v38, v38 row_half_mirror row_mask:0xf bank_mask:0xf
    v_add_f32_dpp v39, v39, v39 row_half_mirror row_mask:0xf bank_mask:0xf
    v_add_f32_dpp v40, v40, v40 row_half_mirror row_mask:0xf bank_mask:0xf
    v_add_f32_dpp v41, v41, v41 row_half_mirror row_mask:0xf bank_mask:0xf
    v_add_f32_dpp v42, v42, v42 row_half_mirror row_mask:0xf bank_mask:0xf
    v_add_f32_dpp v43, v43, v43 row_half_mirror row_mask:0xf bank_mask:0xf
    v_add_f32_dpp v36, v36, v36 row_mirror row_mask:0xf bank_mask:0xf
    v_add_f32_dpp v37, v37, v37 row_mirror row_mask:0xf bank_mask:0xf
    v_add_f32_dpp v38, v38, v38 row_mirror row_mask:0xf bank_mask:0xf
    v_add_f32_dpp v39, v39, v39 row_mirror row_mask:0xf bank_mask:0xf
    v_add_f32_dpp v40, v40, v40 row_mirror row_mask:0xf bank_mask:0xf
    v_add_f32_dpp v41, v41, v41 row_mirror row_mask:0xf bank_mask:0xf
    v_add_f32_dpp v42, v42, v42 row_mirror row_mask:0xf bank_mask:0xf
    v_add_f32_dpp v43, v43, v43 row_mirror row_mask:0xf bank_mask:0xf
    v_cvt_pk_bf16_f32 v36, 0, v36
    v_cvt_pk_bf16_f32 v37, 0, v37
    v_cvt_pk_bf16_f32 v38, 0, v38
    v_cvt_pk_bf16_f32 v39, 0, v39
    v_cvt_pk_bf16_f32 v40, 0, v40
    v_cvt_pk_bf16_f32 v41, 0, v41
    v_cvt_pk_bf16_f32 v42, 0, v42
    v_cvt_pk_bf16_f32 v43, 0, v43
    v_max3_f32 v4, v36, v37, v38
    v_max3_f32 v4, v4, v39, v40
    v_max3_f32 v4, v4, v41, v42
    v_max_f32 v4, v4, v43
    v_max_f32 v4, v4, v60
    v_sub_f32 v5, v60, v4
    v_mul_f32 v5, s14, v5
    v_exp_f32 v5, v5
    v_mov_b32 v60, v4
    v_mul_f32 v61, v61, v5
    v_mul_f32 v20, v20, v5
    v_mul_f32 v21, v21, v5
    v_mul_f32 v22, v22, v5
    v_mul_f32 v23, v23, v5
    v_mul_f32 v24, v24, v5
    v_mul_f32 v25, v25, v5
    v_mul_f32 v26, v26, v5
    v_mul_f32 v27, v27, v5
    v_mul_f32 v28, v28, v5
    v_mul_f32 v29, v29, v5
    v_mul_f32 v30, v30, v5
    v_mul_f32 v31, v31, v5
    v_mul_f32 v32, v32, v5
    v_mul_f32 v33, v33, v5
    v_mul_f32 v34, v34, v5
    v_mul_f32 v35, v35, v5
    v_mul_f32 v6, s14, v60
    v_fma_f32 v36, v36, s14, -v6
    v_fma_f32 v37, v37, s14, -v6
    v_fma_f32 v38, v38, s14, -v6
    v_fma_f32 v39, v39, s14, -v6
    v_fma_f32 v40, v40, s14, -v6
    v_fma_f32 v41, v41, s14, -v6
    v_fma_f32 v42, v42, s14, -v6
    v_fma_f32 v43, v43, s14, -v6
    v_exp_f32 v36, v36
    v_exp_f32 v37, v37
    v_exp_f32 v38, v38
    v_exp_f32 v39, v39
    v_exp_f32 v40, v40
    v_exp_f32 v41, v41
    v_exp_f32 v42, v42
    v_exp_f32 v43, v43
    v_cvt_pk_bf16_f32 v45, 0, v36
    v_cvt_pk_bf16_f32 v44, v36, 0
    v_cvt_pk_bf16_f32 v47, 0, v37
    v_cvt_pk_bf16_f32 v46, v37, 0
    v_cvt_pk_bf16_f32 v49, 0, v38
    v_cvt_pk_bf16_f32 v48, v38, 0
    v_cvt_pk_bf16_f32 v51, 0, v39
    v_cvt_pk_bf16_f32 v50, v39, 0
    v_cvt_pk_bf16_f32 v53, 0, v40
    v_cvt_pk_bf16_f32 v52, v40, 0
    v_cvt_pk_bf16_f32 v55, 0, v41
    v_cvt_pk_bf16_f32 v54, v41, 0
    v_cvt_pk_bf16_f32 v57, 0, v42
    v_cvt_pk_bf16_f32 v56, v42, 0
    v_cvt_pk_bf16_f32 v59, 0, v43
    v_cvt_pk_bf16_f32 v58, v43, 0
    v_add_f32 v61, v61, v45
    v_add_f32 v61, v61, v47
    v_add_f32 v61, v61, v49
    v_add_f32 v61, v61, v51
    v_add_f32 v61, v61, v53
    v_add_f32 v61, v61, v55
    v_add_f32 v61, v61, v57
    v_add_f32 v61, v61, v59
    s_waitcnt vmcnt(22)
    v_dot2c_f32_bf16 v20, v224, v44
    v_dot2c_f32_bf16 v21, v224, v45
    v_dot2c_f32_bf16 v28, v228, v44
    v_dot2c_f32_bf16 v29, v228, v45
    v_dot2c_f32_bf16 v22, v225, v44
    v_dot2c_f32_bf16 v23, v225, v45
    v_dot2c_f32_bf16 v30, v229, v44
    v_dot2c_f32_bf16 v31, v229, v45
    v_dot2c_f32_bf16 v24, v226, v44
    v_dot2c_f32_bf16 v25, v226, v45
    v_dot2c_f32_bf16 v32, v230, v44
    v_dot2c_f32_bf16 v33, v230, v45
    v_dot2c_f32_bf16 v26, v227, v44
    v_dot2c_f32_bf16 v27, v227, v45
    v_dot2c_f32_bf16 v34, v231, v44
    v_dot2c_f32_bf16 v35, v231, v45
    s_mov_b32 s3, 28672
    buffer_load_dwordx4 v[160:163], v1, s[48:51], s3 offen nt
    buffer_load_dwordx4 v[164:167], v1, s[48:51], s3 offen offset:256 nt
    s_mov_b32 s3, 14336
    buffer_load_dwordx4 v[168:171], v3, s[56:59], s3 offen
    buffer_load_dwordx4 v[172:175], v3, s[56:59], s3 offen offset:896
    s_waitcnt vmcnt(22)
    v_dot2c_f32_bf16 v20, v240, v46
    v_dot2c_f32_bf16 v21, v240, v47
    v_dot2c_f32_bf16 v28, v244, v46
    v_dot2c_f32_bf16 v29, v244, v47
    v_dot2c_f32_bf16 v22, v241, v46
    v_dot2c_f32_bf16 v23, v241, v47
    v_dot2c_f32_bf16 v30, v245, v46
    v_dot2c_f32_bf16 v31, v245, v47
    v_dot2c_f32_bf16 v24, v242, v46
    v_dot2c_f32_bf16 v25, v242, v47
    v_dot2c_f32_bf16 v32, v246, v46
    v_dot2c_f32_bf16 v33, v246, v47
    v_dot2c_f32_bf16 v26, v243, v46
    v_dot2c_f32_bf16 v27, v243, v47
    v_dot2c_f32_bf16 v34, v247, v46
    v_dot2c_f32_bf16 v35, v247, v47
    s_mov_b32 s3, 28672
    buffer_load_dwordx4 v[176:179], v1, s[48:51], s3 offen offset:2048 nt
    buffer_load_dwordx4 v[180:183], v1, s[48:51], s3 offen offset:2304 nt
    s_mov_b32 s3, 14336
    buffer_load_dwordx4 v[184:187], v3, s[56:59], s3 offen offset:1792
    buffer_load_dwordx4 v[188:191], v3, s[56:59], s3 offen offset:2688
    s_waitcnt vmcnt(22)
    v_dot2c_f32_bf16 v20, v80, v48
    v_dot2c_f32_bf16 v21, v80, v49
    v_dot2c_f32_bf16 v28, v84, v48
    v_dot2c_f32_bf16 v29, v84, v49
    v_dot2c_f32_bf16 v22, v81, v48
    v_dot2c_f32_bf16 v23, v81, v49
    v_dot2c_f32_bf16 v30, v85, v48
    v_dot2c_f32_bf16 v31, v85, v49
    v_dot2c_f32_bf16 v24, v82, v48
    v_dot2c_f32_bf16 v25, v82, v49
    v_dot2c_f32_bf16 v32, v86, v48
    v_dot2c_f32_bf16 v33, v86, v49
    v_dot2c_f32_bf16 v26, v83, v48
    v_dot2c_f32_bf16 v27, v83, v49
    v_dot2c_f32_bf16 v34, v87, v48
    v_dot2c_f32_bf16 v35, v87, v49
    s_mov_b32 s3, 32768
    buffer_load_dwordx4 v[192:195], v1, s[44:47], s3 offen nt
    buffer_load_dwordx4 v[196:199], v1, s[44:47], s3 offen offset:256 nt
    s_mov_b32 s3, 17920
    buffer_load_dwordx4 v[200:203], v3, s[56:59], s3 offen
    buffer_load_dwordx4 v[204:207], v3, s[56:59], s3 offen offset:896
    s_waitcnt vmcnt(22)
    v_dot2c_f32_bf16 v20, v112, v50
    v_dot2c_f32_bf16 v21, v112, v51
    v_dot2c_f32_bf16 v28, v116, v50
    v_dot2c_f32_bf16 v29, v116, v51
    v_dot2c_f32_bf16 v22, v113, v50
    v_dot2c_f32_bf16 v23, v113, v51
    v_dot2c_f32_bf16 v30, v117, v50
    v_dot2c_f32_bf16 v31, v117, v51
    v_dot2c_f32_bf16 v24, v114, v50
    v_dot2c_f32_bf16 v25, v114, v51
    v_dot2c_f32_bf16 v32, v118, v50
    v_dot2c_f32_bf16 v33, v118, v51
    v_dot2c_f32_bf16 v26, v115, v50
    v_dot2c_f32_bf16 v27, v115, v51
    v_dot2c_f32_bf16 v34, v119, v50
    v_dot2c_f32_bf16 v35, v119, v51
    s_mov_b32 s3, 32768
    buffer_load_dwordx4 v[88:91], v1, s[44:47], s3 offen offset:2048 nt
    buffer_load_dwordx4 v[92:95], v1, s[44:47], s3 offen offset:2304 nt
    s_mov_b32 s3, 17920
    buffer_load_dwordx4 v[208:211], v3, s[56:59], s3 offen offset:1792
    buffer_load_dwordx4 v[212:215], v3, s[56:59], s3 offen offset:2688
    s_waitcnt vmcnt(22)
    v_dot2c_f32_bf16 v20, v128, v52
    v_dot2c_f32_bf16 v21, v128, v53
    v_dot2c_f32_bf16 v28, v132, v52
    v_dot2c_f32_bf16 v29, v132, v53
    v_dot2c_f32_bf16 v22, v129, v52
    v_dot2c_f32_bf16 v23, v129, v53
    v_dot2c_f32_bf16 v30, v133, v52
    v_dot2c_f32_bf16 v31, v133, v53
    v_dot2c_f32_bf16 v24, v130, v52
    v_dot2c_f32_bf16 v25, v130, v53
    v_dot2c_f32_bf16 v32, v134, v52
    v_dot2c_f32_bf16 v33, v134, v53
    v_dot2c_f32_bf16 v26, v131, v52
    v_dot2c_f32_bf16 v27, v131, v53
    v_dot2c_f32_bf16 v34, v135, v52
    v_dot2c_f32_bf16 v35, v135, v53
    s_mov_b32 s3, 36864
    buffer_load_dwordx4 v[224:227], v1, s[44:47], s3 offen nt
    buffer_load_dwordx4 v[228:231], v1, s[44:47], s3 offen offset:256 nt
    s_mov_b32 s3, 21504
    buffer_load_dwordx4 v[240:243], v3, s[56:59], s3 offen
    buffer_load_dwordx4 v[244:247], v3, s[56:59], s3 offen offset:896
    s_waitcnt vmcnt(22)
    v_dot2c_f32_bf16 v20, v144, v54
    v_dot2c_f32_bf16 v21, v144, v55
    v_dot2c_f32_bf16 v28, v148, v54
    v_dot2c_f32_bf16 v29, v148, v55
    v_dot2c_f32_bf16 v22, v145, v54
    v_dot2c_f32_bf16 v23, v145, v55
    v_dot2c_f32_bf16 v30, v149, v54
    v_dot2c_f32_bf16 v31, v149, v55
    v_dot2c_f32_bf16 v24, v146, v54
    v_dot2c_f32_bf16 v25, v146, v55
    v_dot2c_f32_bf16 v32, v150, v54
    v_dot2c_f32_bf16 v33, v150, v55
    v_dot2c_f32_bf16 v26, v147, v54
    v_dot2c_f32_bf16 v27, v147, v55
    v_dot2c_f32_bf16 v34, v151, v54
    v_dot2c_f32_bf16 v35, v151, v55
    s_mov_b32 s3, 36864
    buffer_load_dwordx4 v[80:83], v1, s[44:47], s3 offen offset:2048 nt
    buffer_load_dwordx4 v[84:87], v1, s[44:47], s3 offen offset:2304 nt
    s_mov_b32 s3, 21504
    buffer_load_dwordx4 v[112:115], v3, s[56:59], s3 offen offset:1792
    buffer_load_dwordx4 v[116:119], v3, s[56:59], s3 offen offset:2688
    s_waitcnt vmcnt(22)
    v_dot2c_f32_bf16 v20, v160, v56
    v_dot2c_f32_bf16 v21, v160, v57
    v_dot2c_f32_bf16 v28, v164, v56
    v_dot2c_f32_bf16 v29, v164, v57
    v_dot2c_f32_bf16 v22, v161, v56
    v_dot2c_f32_bf16 v23, v161, v57
    v_dot2c_f32_bf16 v30, v165, v56
    v_dot2c_f32_bf16 v31, v165, v57
    v_dot2c_f32_bf16 v24, v162, v56
    v_dot2c_f32_bf16 v25, v162, v57
    v_dot2c_f32_bf16 v32, v166, v56
    v_dot2c_f32_bf16 v33, v166, v57
    v_dot2c_f32_bf16 v26, v163, v56
    v_dot2c_f32_bf16 v27, v163, v57
    v_dot2c_f32_bf16 v34, v167, v56
    v_dot2c_f32_bf16 v35, v167, v57
    s_mov_b32 s3, 40960
    buffer_load_dwordx4 v[128:131], v1, s[44:47], s3 offen nt
    buffer_load_dwordx4 v[132:135], v1, s[44:47], s3 offen offset:256 nt
    s_mov_b32 s3, 25088
    buffer_load_dwordx4 v[144:147], v3, s[56:59], s3 offen
    buffer_load_dwordx4 v[148:151], v3, s[56:59], s3 offen offset:896
    s_waitcnt vmcnt(22)
    v_dot2c_f32_bf16 v20, v176, v58
    v_dot2c_f32_bf16 v21, v176, v59
    v_dot2c_f32_bf16 v28, v180, v58
    v_dot2c_f32_bf16 v29, v180, v59
    v_dot2c_f32_bf16 v22, v177, v58
    v_dot2c_f32_bf16 v23, v177, v59
    v_dot2c_f32_bf16 v30, v181, v58
    v_dot2c_f32_bf16 v31, v181, v59
    v_dot2c_f32_bf16 v24, v178, v58
    v_dot2c_f32_bf16 v25, v178, v59
    v_dot2c_f32_bf16 v32, v182, v58
    v_dot2c_f32_bf16 v33, v182, v59
    v_dot2c_f32_bf16 v26, v179, v58
    v_dot2c_f32_bf16 v27, v179, v59
    v_dot2c_f32_bf16 v34, v183, v58
    v_dot2c_f32_bf16 v35, v183, v59
    s_mov_b32 s3, 40960
    buffer_load_dwordx4 v[160:163], v1, s[44:47], s3 offen offset:2048 nt
    buffer_load_dwordx4 v[164:167], v1, s[44:47], s3 offen offset:2304 nt
    s_mov_b32 s3, 25088
    buffer_load_dwordx4 v[176:179], v3, s[56:59], s3 offen offset:1792
    buffer_load_dwordx4 v[180:183], v3, s[56:59], s3 offen offset:2688
    v_mov_b32 v36, 0
    v_mov_b32 v37, 0
    v_mov_b32 v38, 0
    v_mov_b32 v39, 0
    v_mov_b32 v40, 0
    v_mov_b32 v41, 0
    v_mov_b32 v42, 0
    v_mov_b32 v43, 0
    s_waitcnt vmcnt(22)
    v_dot2c_f32_bf16 v36, v192, v12
    v_dot2c_f32_bf16 v36, v193, v13
    v_dot2c_f32_bf16 v36, v194, v14
    v_dot2c_f32_bf16 v36, v195, v15
    v_dot2c_f32_bf16 v36, v196, v16
    v_dot2c_f32_bf16 v36, v197, v17
    v_dot2c_f32_bf16 v36, v198, v18
    v_dot2c_f32_bf16 v36, v199, v19
    s_mov_b32 s3, 45056
    buffer_load_dwordx4 v[192:195], v1, s[44:47], s3 offen nt
    buffer_load_dwordx4 v[196:199], v1, s[44:47], s3 offen offset:256 nt
    s_waitcnt vmcnt(20)
    v_dot2c_f32_bf16 v37, v88, v12
    v_dot2c_f32_bf16 v37, v89, v13
    v_dot2c_f32_bf16 v37, v90, v14
    v_dot2c_f32_bf16 v37, v91, v15
    v_dot2c_f32_bf16 v37, v92, v16
    v_dot2c_f32_bf16 v37, v93, v17
    v_dot2c_f32_bf16 v37, v94, v18
    v_dot2c_f32_bf16 v37, v95, v19
    buffer_load_dwordx4 v[88:91], v1, s[44:47], s3 offen offset:2048 nt
    buffer_load_dwordx4 v[92:95], v1, s[44:47], s3 offen offset:2304 nt
    s_waitcnt vmcnt(18)
    v_dot2c_f32_bf16 v38, v224, v12
    v_dot2c_f32_bf16 v38, v225, v13
    v_dot2c_f32_bf16 v38, v226, v14
    v_dot2c_f32_bf16 v38, v227, v15
    v_dot2c_f32_bf16 v38, v228, v16
    v_dot2c_f32_bf16 v38, v229, v17
    v_dot2c_f32_bf16 v38, v230, v18
    v_dot2c_f32_bf16 v38, v231, v19
    s_mov_b32 s3, 32768
    buffer_load_dwordx4 v[224:227], v1, s[48:51], s3 offen nt
    buffer_load_dwordx4 v[228:231], v1, s[48:51], s3 offen offset:256 nt
    s_waitcnt vmcnt(16)
    v_dot2c_f32_bf16 v39, v80, v12
    v_dot2c_f32_bf16 v39, v81, v13
    v_dot2c_f32_bf16 v39, v82, v14
    v_dot2c_f32_bf16 v39, v83, v15
    v_dot2c_f32_bf16 v39, v84, v16
    v_dot2c_f32_bf16 v39, v85, v17
    v_dot2c_f32_bf16 v39, v86, v18
    v_dot2c_f32_bf16 v39, v87, v19
    buffer_load_dwordx4 v[80:83], v1, s[48:51], s3 offen offset:2048 nt
    buffer_load_dwordx4 v[84:87], v1, s[48:51], s3 offen offset:2304 nt
    s_waitcnt vmcnt(14)
    v_dot2c_f32_bf16 v40, v128, v12
    v_dot2c_f32_bf16 v40, v129, v13
    v_dot2c_f32_bf16 v40, v130, v14
    v_dot2c_f32_bf16 v40, v131, v15
    v_dot2c_f32_bf16 v40, v132, v16
    v_dot2c_f32_bf16 v40, v133, v17
    v_dot2c_f32_bf16 v40, v134, v18
    v_dot2c_f32_bf16 v40, v135, v19
    s_mov_b32 s3, 36864
    buffer_load_dwordx4 v[128:131], v1, s[48:51], s3 offen nt
    buffer_load_dwordx4 v[132:135], v1, s[48:51], s3 offen offset:256 nt
    s_waitcnt vmcnt(12)
    v_dot2c_f32_bf16 v41, v160, v12
    v_dot2c_f32_bf16 v41, v161, v13
    v_dot2c_f32_bf16 v41, v162, v14
    v_dot2c_f32_bf16 v41, v163, v15
    v_dot2c_f32_bf16 v41, v164, v16
    v_dot2c_f32_bf16 v41, v165, v17
    v_dot2c_f32_bf16 v41, v166, v18
    v_dot2c_f32_bf16 v41, v167, v19
    buffer_load_dwordx4 v[160:163], v1, s[48:51], s3 offen offset:2048 nt
    buffer_load_dwordx4 v[164:167], v1, s[48:51], s3 offen offset:2304 nt
    s_waitcnt vmcnt(10)
    v_dot2c_f32_bf16 v42, v192, v12
    v_dot2c_f32_bf16 v42, v193, v13
    v_dot2c_f32_bf16 v42, v194, v14
    v_dot2c_f32_bf16 v42, v195, v15
    v_dot2c_f32_bf16 v42, v196, v16
    v_dot2c_f32_bf16 v42, v197, v17
    v_dot2c_f32_bf16 v42, v198, v18
    v_dot2c_f32_bf16 v42, v199, v19
    s_mov_b32 s3, 40960
    buffer_load_dwordx4 v[192:195], v1, s[48:51], s3 offen nt
    buffer_load_dwordx4 v[196:199], v1, s[48:51], s3 offen offset:256 nt
    s_waitcnt vmcnt(10)
    v_dot2c_f32_bf16 v43, v88, v12
    v_dot2c_f32_bf16 v43, v89, v13
    v_dot2c_f32_bf16 v43, v90, v14
    v_dot2c_f32_bf16 v43, v91, v15
    v_dot2c_f32_bf16 v43, v92, v16
    v_dot2c_f32_bf16 v43, v93, v17
    v_dot2c_f32_bf16 v43, v94, v18
    v_dot2c_f32_bf16 v43, v95, v19
    buffer_load_dwordx4 v[88:91], v1, s[48:51], s3 offen offset:2048 nt
    buffer_load_dwordx4 v[92:95], v1, s[48:51], s3 offen offset:2304 nt
    v_add_f32_dpp v36, v36, v36 quad_perm:[1,0,3,2] row_mask:0xf bank_mask:0xf
    v_add_f32_dpp v37, v37, v37 quad_perm:[1,0,3,2] row_mask:0xf bank_mask:0xf
    v_add_f32_dpp v38, v38, v38 quad_perm:[1,0,3,2] row_mask:0xf bank_mask:0xf
    v_add_f32_dpp v39, v39, v39 quad_perm:[1,0,3,2] row_mask:0xf bank_mask:0xf
    v_add_f32_dpp v40, v40, v40 quad_perm:[1,0,3,2] row_mask:0xf bank_mask:0xf
    v_add_f32_dpp v41, v41, v41 quad_perm:[1,0,3,2] row_mask:0xf bank_mask:0xf
    v_add_f32_dpp v42, v42, v42 quad_perm:[1,0,3,2] row_mask:0xf bank_mask:0xf
    v_add_f32_dpp v43, v43, v43 quad_perm:[1,0,3,2] row_mask:0xf bank_mask:0xf
    v_add_f32_dpp v36, v36, v36 quad_perm:[2,3,0,1] row_mask:0xf bank_mask:0xf
    v_add_f32_dpp v37, v37, v37 quad_perm:[2,3,0,1] row_mask:0xf bank_mask:0xf
    v_add_f32_dpp v38, v38, v38 quad_perm:[2,3,0,1] row_mask:0xf bank_mask:0xf
    v_add_f32_dpp v39, v39, v39 quad_perm:[2,3,0,1] row_mask:0xf bank_mask:0xf
    v_add_f32_dpp v40, v40, v40 quad_perm:[2,3,0,1] row_mask:0xf bank_mask:0xf
    v_add_f32_dpp v41, v41, v41 quad_perm:[2,3,0,1] row_mask:0xf bank_mask:0xf
    v_add_f32_dpp v42, v42, v42 quad_perm:[2,3,0,1] row_mask:0xf bank_mask:0xf
    v_add_f32_dpp v43, v43, v43 quad_perm:[2,3,0,1] row_mask:0xf bank_mask:0xf
    v_add_f32_dpp v36, v36, v36 row_half_mirror row_mask:0xf bank_mask:0xf
    v_add_f32_dpp v37, v37, v37 row_half_mirror row_mask:0xf bank_mask:0xf
    v_add_f32_dpp v38, v38, v38 row_half_mirror row_mask:0xf bank_mask:0xf
    v_add_f32_dpp v39, v39, v39 row_half_mirror row_mask:0xf bank_mask:0xf
    v_add_f32_dpp v40, v40, v40 row_half_mirror row_mask:0xf bank_mask:0xf
    v_add_f32_dpp v41, v41, v41 row_half_mirror row_mask:0xf bank_mask:0xf
    v_add_f32_dpp v42, v42, v42 row_half_mirror row_mask:0xf bank_mask:0xf
    v_add_f32_dpp v43, v43, v43 row_half_mirror row_mask:0xf bank_mask:0xf
    v_add_f32_dpp v36, v36, v36 row_mirror row_mask:0xf bank_mask:0xf
    v_add_f32_dpp v37, v37, v37 row_mirror row_mask:0xf bank_mask:0xf
    v_add_f32_dpp v38, v38, v38 row_mirror row_mask:0xf bank_mask:0xf
    v_add_f32_dpp v39, v39, v39 row_mirror row_mask:0xf bank_mask:0xf
    v_add_f32_dpp v40, v40, v40 row_mirror row_mask:0xf bank_mask:0xf
    v_add_f32_dpp v41, v41, v41 row_mirror row_mask:0xf bank_mask:0xf
    v_add_f32_dpp v42, v42, v42 row_mirror row_mask:0xf bank_mask:0xf
    v_add_f32_dpp v43, v43, v43 row_mirror row_mask:0xf bank_mask:0xf
    v_cvt_pk_bf16_f32 v36, 0, v36
    v_cvt_pk_bf16_f32 v37, 0, v37
    v_cvt_pk_bf16_f32 v38, 0, v38
    v_cvt_pk_bf16_f32 v39, 0, v39
    v_cvt_pk_bf16_f32 v40, 0, v40
    v_cvt_pk_bf16_f32 v41, 0, v41
    v_cvt_pk_bf16_f32 v42, 0, v42
    v_cvt_pk_bf16_f32 v43, 0, v43
    v_max3_f32 v4, v36, v37, v38
    v_max3_f32 v4, v4, v39, v40
    v_max3_f32 v4, v4, v41, v42
    v_max_f32 v4, v4, v43
    v_max_f32 v4, v4, v60
    v_sub_f32 v5, v60, v4
    v_mul_f32 v5, s14, v5
    v_exp_f32 v5, v5
    v_mov_b32 v60, v4
    v_mul_f32 v61, v61, v5
    v_mul_f32 v20, v20, v5
    v_mul_f32 v21, v21, v5
    v_mul_f32 v22, v22, v5
    v_mul_f32 v23, v23, v5
    v_mul_f32 v24, v24, v5
    v_mul_f32 v25, v25, v5
    v_mul_f32 v26, v26, v5
    v_mul_f32 v27, v27, v5
    v_mul_f32 v28, v28, v5
    v_mul_f32 v29, v29, v5
    v_mul_f32 v30, v30, v5
    v_mul_f32 v31, v31, v5
    v_mul_f32 v32, v32, v5
    v_mul_f32 v33, v33, v5
    v_mul_f32 v34, v34, v5
    v_mul_f32 v35, v35, v5
    v_mul_f32 v6, s14, v60
    v_fma_f32 v36, v36, s14, -v6
    v_fma_f32 v37, v37, s14, -v6
    v_fma_f32 v38, v38, s14, -v6
    v_fma_f32 v39, v39, s14, -v6
    v_fma_f32 v40, v40, s14, -v6
    v_fma_f32 v41, v41, s14, -v6
    v_fma_f32 v42, v42, s14, -v6
    v_fma_f32 v43, v43, s14, -v6
    v_exp_f32 v36, v36
    v_exp_f32 v37, v37
    v_exp_f32 v38, v38
    v_exp_f32 v39, v39
    v_exp_f32 v40, v40
    v_exp_f32 v41, v41
    v_exp_f32 v42, v42
    v_exp_f32 v43, v43
    v_cvt_pk_bf16_f32 v45, 0, v36
    v_cvt_pk_bf16_f32 v44, v36, 0
    v_cvt_pk_bf16_f32 v47, 0, v37
    v_cvt_pk_bf16_f32 v46, v37, 0
    v_cvt_pk_bf16_f32 v49, 0, v38
    v_cvt_pk_bf16_f32 v48, v38, 0
    v_cvt_pk_bf16_f32 v51, 0, v39
    v_cvt_pk_bf16_f32 v50, v39, 0
    v_cvt_pk_bf16_f32 v53, 0, v40
    v_cvt_pk_bf16_f32 v52, v40, 0
    v_cvt_pk_bf16_f32 v55, 0, v41
    v_cvt_pk_bf16_f32 v54, v41, 0
    v_cvt_pk_bf16_f32 v57, 0, v42
    v_cvt_pk_bf16_f32 v56, v42, 0
    v_cvt_pk_bf16_f32 v59, 0, v43
    v_cvt_pk_bf16_f32 v58, v43, 0
    v_add_f32 v61, v61, v45
    v_add_f32 v61, v61, v47
    v_add_f32 v61, v61, v49
    v_add_f32 v61, v61, v51
    v_add_f32 v61, v61, v53
    v_add_f32 v61, v61, v55
    v_add_f32 v61, v61, v57
    v_add_f32 v61, v61, v59
    s_waitcnt vmcnt(10)
    v_dot2c_f32_bf16 v20, v224, v44
    v_dot2c_f32_bf16 v21, v224, v45
    v_dot2c_f32_bf16 v28, v228, v44
    v_dot2c_f32_bf16 v29, v228, v45
    v_dot2c_f32_bf16 v22, v225, v44
    v_dot2c_f32_bf16 v23, v225, v45
    v_dot2c_f32_bf16 v30, v229, v44
    v_dot2c_f32_bf16 v31, v229, v45
    v_dot2c_f32_bf16 v24, v226, v44
    v_dot2c_f32_bf16 v25, v226, v45
    v_dot2c_f32_bf16 v32, v230, v44
    v_dot2c_f32_bf16 v33, v230, v45
    v_dot2c_f32_bf16 v26, v227, v44
    v_dot2c_f32_bf16 v27, v227, v45
    v_dot2c_f32_bf16 v34, v231, v44
    v_dot2c_f32_bf16 v35, v231, v45
    s_mov_b32 s3, 45056
    buffer_load_dwordx4 v[224:227], v1, s[48:51], s3 offen nt
    buffer_load_dwordx4 v[228:231], v1, s[48:51], s3 offen offset:256 nt
    s_waitcnt vmcnt(10)
    v_dot2c_f32_bf16 v20, v80, v46
    v_dot2c_f32_bf16 v21, v80, v47
    v_dot2c_f32_bf16 v28, v84, v46
    v_dot2c_f32_bf16 v29, v84, v47
    v_dot2c_f32_bf16 v22, v81, v46
    v_dot2c_f32_bf16 v23, v81, v47
    v_dot2c_f32_bf16 v30, v85, v46
    v_dot2c_f32_bf16 v31, v85, v47
    v_dot2c_f32_bf16 v24, v82, v46
    v_dot2c_f32_bf16 v25, v82, v47
    v_dot2c_f32_bf16 v32, v86, v46
    v_dot2c_f32_bf16 v33, v86, v47
    v_dot2c_f32_bf16 v26, v83, v46
    v_dot2c_f32_bf16 v27, v83, v47
    v_dot2c_f32_bf16 v34, v87, v46
    v_dot2c_f32_bf16 v35, v87, v47
    buffer_load_dwordx4 v[80:83], v1, s[48:51], s3 offen offset:2048 nt
    buffer_load_dwordx4 v[84:87], v1, s[48:51], s3 offen offset:2304 nt
    s_waitcnt vmcnt(10)
    v_dot2c_f32_bf16 v20, v128, v48
    v_dot2c_f32_bf16 v21, v128, v49
    v_dot2c_f32_bf16 v28, v132, v48
    v_dot2c_f32_bf16 v29, v132, v49
    v_dot2c_f32_bf16 v22, v129, v48
    v_dot2c_f32_bf16 v23, v129, v49
    v_dot2c_f32_bf16 v30, v133, v48
    v_dot2c_f32_bf16 v31, v133, v49
    v_dot2c_f32_bf16 v24, v130, v48
    v_dot2c_f32_bf16 v25, v130, v49
    v_dot2c_f32_bf16 v32, v134, v48
    v_dot2c_f32_bf16 v33, v134, v49
    v_dot2c_f32_bf16 v26, v131, v48
    v_dot2c_f32_bf16 v27, v131, v49
    v_dot2c_f32_bf16 v34, v135, v48
    v_dot2c_f32_bf16 v35, v135, v49
    s_mov_b32 s3, 49152
    buffer_load_dwordx4 v[128:131], v1, s[44:47], s3 offen nt
    buffer_load_dwordx4 v[132:135], v1, s[44:47], s3 offen offset:256 nt
    s_waitcnt vmcnt(10)
    v_dot2c_f32_bf16 v20, v160, v50
    v_dot2c_f32_bf16 v21, v160, v51
    v_dot2c_f32_bf16 v28, v164, v50
    v_dot2c_f32_bf16 v29, v164, v51
    v_dot2c_f32_bf16 v22, v161, v50
    v_dot2c_f32_bf16 v23, v161, v51
    v_dot2c_f32_bf16 v30, v165, v50
    v_dot2c_f32_bf16 v31, v165, v51
    v_dot2c_f32_bf16 v24, v162, v50
    v_dot2c_f32_bf16 v25, v162, v51
    v_dot2c_f32_bf16 v32, v166, v50
    v_dot2c_f32_bf16 v33, v166, v51
    v_dot2c_f32_bf16 v26, v163, v50
    v_dot2c_f32_bf16 v27, v163, v51
    v_dot2c_f32_bf16 v34, v167, v50
    v_dot2c_f32_bf16 v35, v167, v51
    buffer_load_dwordx4 v[160:163], v1, s[44:47], s3 offen offset:2048 nt
    buffer_load_dwordx4 v[164:167], v1, s[44:47], s3 offen offset:2304 nt
    s_waitcnt vmcnt(10)
    v_dot2c_f32_bf16 v20, v192, v52
    v_dot2c_f32_bf16 v21, v192, v53
    v_dot2c_f32_bf16 v28, v196, v52
    v_dot2c_f32_bf16 v29, v196, v53
    v_dot2c_f32_bf16 v22, v193, v52
    v_dot2c_f32_bf16 v23, v193, v53
    v_dot2c_f32_bf16 v30, v197, v52
    v_dot2c_f32_bf16 v31, v197, v53
    v_dot2c_f32_bf16 v24, v194, v52
    v_dot2c_f32_bf16 v25, v194, v53
    v_dot2c_f32_bf16 v32, v198, v52
    v_dot2c_f32_bf16 v33, v198, v53
    v_dot2c_f32_bf16 v26, v195, v52
    v_dot2c_f32_bf16 v27, v195, v53
    v_dot2c_f32_bf16 v34, v199, v52
    v_dot2c_f32_bf16 v35, v199, v53
    s_mov_b32 s3, 53248
    buffer_load_dwordx4 v[192:195], v1, s[44:47], s3 offen nt
    buffer_load_dwordx4 v[196:199], v1, s[44:47], s3 offen offset:256 nt
    s_waitcnt vmcnt(10)
    v_dot2c_f32_bf16 v20, v88, v54
    v_dot2c_f32_bf16 v21, v88, v55
    v_dot2c_f32_bf16 v28, v92, v54
    v_dot2c_f32_bf16 v29, v92, v55
    v_dot2c_f32_bf16 v22, v89, v54
    v_dot2c_f32_bf16 v23, v89, v55
    v_dot2c_f32_bf16 v30, v93, v54
    v_dot2c_f32_bf16 v31, v93, v55
    v_dot2c_f32_bf16 v24, v90, v54
    v_dot2c_f32_bf16 v25, v90, v55
    v_dot2c_f32_bf16 v32, v94, v54
    v_dot2c_f32_bf16 v33, v94, v55
    v_dot2c_f32_bf16 v26, v91, v54
    v_dot2c_f32_bf16 v27, v91, v55
    v_dot2c_f32_bf16 v34, v95, v54
    v_dot2c_f32_bf16 v35, v95, v55
    buffer_load_dwordx4 v[88:91], v1, s[44:47], s3 offen offset:2048 nt
    buffer_load_dwordx4 v[92:95], v1, s[44:47], s3 offen offset:2304 nt
    s_waitcnt vmcnt(10)
    v_dot2c_f32_bf16 v20, v224, v56
    v_dot2c_f32_bf16 v21, v224, v57
    v_dot2c_f32_bf16 v28, v228, v56
    v_dot2c_f32_bf16 v29, v228, v57
    v_dot2c_f32_bf16 v22, v225, v56
    v_dot2c_f32_bf16 v23, v225, v57
    v_dot2c_f32_bf16 v30, v229, v56
    v_dot2c_f32_bf16 v31, v229, v57
    v_dot2c_f32_bf16 v24, v226, v56
    v_dot2c_f32_bf16 v25, v226, v57
    v_dot2c_f32_bf16 v32, v230, v56
    v_dot2c_f32_bf16 v33, v230, v57
    v_dot2c_f32_bf16 v26, v227, v56
    v_dot2c_f32_bf16 v27, v227, v57
    v_dot2c_f32_bf16 v34, v231, v56
    v_dot2c_f32_bf16 v35, v231, v57
    s_mov_b32 s3, 57344
    buffer_load_dwordx4 v[224:227], v1, s[44:47], s3 offen nt
    buffer_load_dwordx4 v[228:231], v1, s[44:47], s3 offen offset:256 nt
    s_waitcnt vmcnt(10)
    v_dot2c_f32_bf16 v20, v80, v58
    v_dot2c_f32_bf16 v21, v80, v59
    v_dot2c_f32_bf16 v28, v84, v58
    v_dot2c_f32_bf16 v29, v84, v59
    v_dot2c_f32_bf16 v22, v81, v58
    v_dot2c_f32_bf16 v23, v81, v59
    v_dot2c_f32_bf16 v30, v85, v58
    v_dot2c_f32_bf16 v31, v85, v59
    v_dot2c_f32_bf16 v24, v82, v58
    v_dot2c_f32_bf16 v25, v82, v59
    v_dot2c_f32_bf16 v32, v86, v58
    v_dot2c_f32_bf16 v33, v86, v59
    v_dot2c_f32_bf16 v26, v83, v58
    v_dot2c_f32_bf16 v27, v83, v59
    v_dot2c_f32_bf16 v34, v87, v58
    v_dot2c_f32_bf16 v35, v87, v59
    buffer_load_dwordx4 v[80:83], v1, s[44:47], s3 offen offset:2048 nt
    buffer_load_dwordx4 v[84:87], v1, s[44:47], s3 offen offset:2304 nt
    v_mov_b32 v36, 0
    v_mov_b32 v37, 0
    v_mov_b32 v38, 0
    v_mov_b32 v39, 0
    v_mov_b32 v40, 0
    v_mov_b32 v41, 0
    v_mov_b32 v42, 0
    v_mov_b32 v43, 0
    s_waitcnt vmcnt(10)
    v_dot2c_f32_bf16 v36, v128, v12
    v_dot2c_f32_bf16 v36, v129, v13
    v_dot2c_f32_bf16 v36, v130, v14
    v_dot2c_f32_bf16 v36, v131, v15
    v_dot2c_f32_bf16 v36, v132, v16
    v_dot2c_f32_bf16 v36, v133, v17
    v_dot2c_f32_bf16 v36, v134, v18
    v_dot2c_f32_bf16 v36, v135, v19
    s_mov_b32 s3, 61440
    buffer_load_dwordx4 v[128:131], v1, s[44:47], s3 offen nt
    buffer_load_dwordx4 v[132:135], v1, s[44:47], s3 offen offset:256 nt
    s_waitcnt vmcnt(10)
    v_dot2c_f32_bf16 v37, v160, v12
    v_dot2c_f32_bf16 v37, v161, v13
    v_dot2c_f32_bf16 v37, v162, v14
    v_dot2c_f32_bf16 v37, v163, v15
    v_dot2c_f32_bf16 v37, v164, v16
    v_dot2c_f32_bf16 v37, v165, v17
    v_dot2c_f32_bf16 v37, v166, v18
    v_dot2c_f32_bf16 v37, v167, v19
    buffer_load_dwordx4 v[160:163], v1, s[44:47], s3 offen offset:2048 nt
    buffer_load_dwordx4 v[164:167], v1, s[44:47], s3 offen offset:2304 nt
    s_waitcnt vmcnt(10)
    v_dot2c_f32_bf16 v38, v192, v12
    v_dot2c_f32_bf16 v38, v193, v13
    v_dot2c_f32_bf16 v38, v194, v14
    v_dot2c_f32_bf16 v38, v195, v15
    v_dot2c_f32_bf16 v38, v196, v16
    v_dot2c_f32_bf16 v38, v197, v17
    v_dot2c_f32_bf16 v38, v198, v18
    v_dot2c_f32_bf16 v38, v199, v19
    s_mov_b32 s3, 49152
    buffer_load_dwordx4 v[192:195], v1, s[48:51], s3 offen nt
    buffer_load_dwordx4 v[196:199], v1, s[48:51], s3 offen offset:256 nt
    s_waitcnt vmcnt(10)
    v_dot2c_f32_bf16 v39, v88, v12
    v_dot2c_f32_bf16 v39, v89, v13
    v_dot2c_f32_bf16 v39, v90, v14
    v_dot2c_f32_bf16 v39, v91, v15
    v_dot2c_f32_bf16 v39, v92, v16
    v_dot2c_f32_bf16 v39, v93, v17
    v_dot2c_f32_bf16 v39, v94, v18
    v_dot2c_f32_bf16 v39, v95, v19
    buffer_load_dwordx4 v[88:91], v1, s[48:51], s3 offen offset:2048 nt
    buffer_load_dwordx4 v[92:95], v1, s[48:51], s3 offen offset:2304 nt
    s_waitcnt vmcnt(10)
    v_dot2c_f32_bf16 v40, v224, v12
    v_dot2c_f32_bf16 v40, v225, v13
    v_dot2c_f32_bf16 v40, v226, v14
    v_dot2c_f32_bf16 v40, v227, v15
    v_dot2c_f32_bf16 v40, v228, v16
    v_dot2c_f32_bf16 v40, v229, v17
    v_dot2c_f32_bf16 v40, v230, v18
    v_dot2c_f32_bf16 v40, v231, v19
    s_mov_b32 s3, 53248
    buffer_load_dwordx4 v[224:227], v1, s[48:51], s3 offen nt
    buffer_load_dwordx4 v[228:231], v1, s[48:51], s3 offen offset:256 nt
    s_waitcnt vmcnt(10)
    v_dot2c_f32_bf16 v41, v80, v12
    v_dot2c_f32_bf16 v41, v81, v13
    v_dot2c_f32_bf16 v41, v82, v14
    v_dot2c_f32_bf16 v41, v83, v15
    v_dot2c_f32_bf16 v41, v84, v16
    v_dot2c_f32_bf16 v41, v85, v17
    v_dot2c_f32_bf16 v41, v86, v18
    v_dot2c_f32_bf16 v41, v87, v19
    buffer_load_dwordx4 v[80:83], v1, s[48:51], s3 offen offset:2048 nt
    buffer_load_dwordx4 v[84:87], v1, s[48:51], s3 offen offset:2304 nt
    s_waitcnt vmcnt(10)
    v_dot2c_f32_bf16 v42, v128, v12
    v_dot2c_f32_bf16 v42, v129, v13
    v_dot2c_f32_bf16 v42, v130, v14
    v_dot2c_f32_bf16 v42, v131, v15
    v_dot2c_f32_bf16 v42, v132, v16
    v_dot2c_f32_bf16 v42, v133, v17
    v_dot2c_f32_bf16 v42, v134, v18
    v_dot2c_f32_bf16 v42, v135, v19
    s_mov_b32 s3, 57344
    buffer_load_dwordx4 v[128:131], v1, s[48:51], s3 offen nt
    buffer_load_dwordx4 v[132:135], v1, s[48:51], s3 offen offset:256 nt
    s_waitcnt vmcnt(10)
    v_dot2c_f32_bf16 v43, v160, v12
    v_dot2c_f32_bf16 v43, v161, v13
    v_dot2c_f32_bf16 v43, v162, v14
    v_dot2c_f32_bf16 v43, v163, v15
    v_dot2c_f32_bf16 v43, v164, v16
    v_dot2c_f32_bf16 v43, v165, v17
    v_dot2c_f32_bf16 v43, v166, v18
    v_dot2c_f32_bf16 v43, v167, v19
    buffer_load_dwordx4 v[160:163], v1, s[48:51], s3 offen offset:2048 nt
    buffer_load_dwordx4 v[164:167], v1, s[48:51], s3 offen offset:2304 nt
    v_add_f32_dpp v36, v36, v36 quad_perm:[1,0,3,2] row_mask:0xf bank_mask:0xf
    v_add_f32_dpp v37, v37, v37 quad_perm:[1,0,3,2] row_mask:0xf bank_mask:0xf
    v_add_f32_dpp v38, v38, v38 quad_perm:[1,0,3,2] row_mask:0xf bank_mask:0xf
    v_add_f32_dpp v39, v39, v39 quad_perm:[1,0,3,2] row_mask:0xf bank_mask:0xf
    v_add_f32_dpp v40, v40, v40 quad_perm:[1,0,3,2] row_mask:0xf bank_mask:0xf
    v_add_f32_dpp v41, v41, v41 quad_perm:[1,0,3,2] row_mask:0xf bank_mask:0xf
    v_add_f32_dpp v42, v42, v42 quad_perm:[1,0,3,2] row_mask:0xf bank_mask:0xf
    v_add_f32_dpp v43, v43, v43 quad_perm:[1,0,3,2] row_mask:0xf bank_mask:0xf
    v_add_f32_dpp v36, v36, v36 quad_perm:[2,3,0,1] row_mask:0xf bank_mask:0xf
    v_add_f32_dpp v37, v37, v37 quad_perm:[2,3,0,1] row_mask:0xf bank_mask:0xf
    v_add_f32_dpp v38, v38, v38 quad_perm:[2,3,0,1] row_mask:0xf bank_mask:0xf
    v_add_f32_dpp v39, v39, v39 quad_perm:[2,3,0,1] row_mask:0xf bank_mask:0xf
    v_add_f32_dpp v40, v40, v40 quad_perm:[2,3,0,1] row_mask:0xf bank_mask:0xf
    v_add_f32_dpp v41, v41, v41 quad_perm:[2,3,0,1] row_mask:0xf bank_mask:0xf
    v_add_f32_dpp v42, v42, v42 quad_perm:[2,3,0,1] row_mask:0xf bank_mask:0xf
    v_add_f32_dpp v43, v43, v43 quad_perm:[2,3,0,1] row_mask:0xf bank_mask:0xf
    v_add_f32_dpp v36, v36, v36 row_half_mirror row_mask:0xf bank_mask:0xf
    v_add_f32_dpp v37, v37, v37 row_half_mirror row_mask:0xf bank_mask:0xf
    v_add_f32_dpp v38, v38, v38 row_half_mirror row_mask:0xf bank_mask:0xf
    v_add_f32_dpp v39, v39, v39 row_half_mirror row_mask:0xf bank_mask:0xf
    v_add_f32_dpp v40, v40, v40 row_half_mirror row_mask:0xf bank_mask:0xf
    v_add_f32_dpp v41, v41, v41 row_half_mirror row_mask:0xf bank_mask:0xf
    v_add_f32_dpp v42, v42, v42 row_half_mirror row_mask:0xf bank_mask:0xf
    v_add_f32_dpp v43, v43, v43 row_half_mirror row_mask:0xf bank_mask:0xf
    v_add_f32_dpp v36, v36, v36 row_mirror row_mask:0xf bank_mask:0xf
    v_add_f32_dpp v37, v37, v37 row_mirror row_mask:0xf bank_mask:0xf
    v_add_f32_dpp v38, v38, v38 row_mirror row_mask:0xf bank_mask:0xf
    v_add_f32_dpp v39, v39, v39 row_mirror row_mask:0xf bank_mask:0xf
    v_add_f32_dpp v40, v40, v40 row_mirror row_mask:0xf bank_mask:0xf
    v_add_f32_dpp v41, v41, v41 row_mirror row_mask:0xf bank_mask:0xf
    v_add_f32_dpp v42, v42, v42 row_mirror row_mask:0xf bank_mask:0xf
    v_add_f32_dpp v43, v43, v43 row_mirror row_mask:0xf bank_mask:0xf
    v_cvt_pk_bf16_f32 v36, 0, v36
    v_cvt_pk_bf16_f32 v37, 0, v37
    v_cvt_pk_bf16_f32 v38, 0, v38
    v_cvt_pk_bf16_f32 v39, 0, v39
    v_cvt_pk_bf16_f32 v40, 0, v40
    v_cvt_pk_bf16_f32 v41, 0, v41
    v_cvt_pk_bf16_f32 v42, 0, v42
    v_cvt_pk_bf16_f32 v43, 0, v43
    v_max3_f32 v4, v36, v37, v38
    v_max3_f32 v4, v4, v39, v40
    v_max3_f32 v4, v4, v41, v42
    v_max_f32 v4, v4, v43
    v_max_f32 v4, v4, v60
    v_sub_f32 v5, v60, v4
    v_mul_f32 v5, s14, v5
    v_exp_f32 v5, v5
    v_mov_b32 v60, v4
    v_mul_f32 v61, v61, v5
    v_mul_f32 v20, v20, v5
    v_mul_f32 v21, v21, v5
    v_mul_f32 v22, v22, v5
    v_mul_f32 v23, v23, v5
    v_mul_f32 v24, v24, v5
    v_mul_f32 v25, v25, v5
    v_mul_f32 v26, v26, v5
    v_mul_f32 v27, v27, v5
    v_mul_f32 v28, v28, v5
    v_mul_f32 v29, v29, v5
    v_mul_f32 v30, v30, v5
    v_mul_f32 v31, v31, v5
    v_mul_f32 v32, v32, v5
    v_mul_f32 v33, v33, v5
    v_mul_f32 v34, v34, v5
    v_mul_f32 v35, v35, v5
    v_mul_f32 v6, s14, v60
    v_fma_f32 v36, v36, s14, -v6
    v_fma_f32 v37, v37, s14, -v6
    v_fma_f32 v38, v38, s14, -v6
    v_fma_f32 v39, v39, s14, -v6
    v_fma_f32 v40, v40, s14, -v6
    v_fma_f32 v41, v41, s14, -v6
    v_fma_f32 v42, v42, s14, -v6
    v_fma_f32 v43, v43, s14, -v6
    v_exp_f32 v36, v36
    v_exp_f32 v37, v37
    v_exp_f32 v38, v38
    v_exp_f32 v39, v39
    v_exp_f32 v40, v40
    v_exp_f32 v41, v41
    v_exp_f32 v42, v42
    v_exp_f32 v43, v43
    v_cvt_pk_bf16_f32 v45, 0, v36
    v_cvt_pk_bf16_f32 v44, v36, 0
    v_cvt_pk_bf16_f32 v47, 0, v37
    v_cvt_pk_bf16_f32 v46, v37, 0
    v_cvt_pk_bf16_f32 v49, 0, v38
    v_cvt_pk_bf16_f32 v48, v38, 0
    v_cvt_pk_bf16_f32 v51, 0, v39
    v_cvt_pk_bf16_f32 v50, v39, 0
    v_cvt_pk_bf16_f32 v53, 0, v40
    v_cvt_pk_bf16_f32 v52, v40, 0
    v_cvt_pk_bf16_f32 v55, 0, v41
    v_cvt_pk_bf16_f32 v54, v41, 0
    v_cvt_pk_bf16_f32 v57, 0, v42
    v_cvt_pk_bf16_f32 v56, v42, 0
    v_cvt_pk_bf16_f32 v59, 0, v43
    v_cvt_pk_bf16_f32 v58, v43, 0
    v_add_f32 v61, v61, v45
    v_add_f32 v61, v61, v47
    v_add_f32 v61, v61, v49
    v_add_f32 v61, v61, v51
    v_add_f32 v61, v61, v53
    v_add_f32 v61, v61, v55
    v_add_f32 v61, v61, v57
    v_add_f32 v61, v61, v59
    s_waitcnt vmcnt(10)
    v_dot2c_f32_bf16 v20, v192, v44
    v_dot2c_f32_bf16 v21, v192, v45
    v_dot2c_f32_bf16 v28, v196, v44
    v_dot2c_f32_bf16 v29, v196, v45
    v_dot2c_f32_bf16 v22, v193, v44
    v_dot2c_f32_bf16 v23, v193, v45
    v_dot2c_f32_bf16 v30, v197, v44
    v_dot2c_f32_bf16 v31, v197, v45
    v_dot2c_f32_bf16 v24, v194, v44
    v_dot2c_f32_bf16 v25, v194, v45
    v_dot2c_f32_bf16 v32, v198, v44
    v_dot2c_f32_bf16 v33, v198, v45
    v_dot2c_f32_bf16 v26, v195, v44
    v_dot2c_f32_bf16 v27, v195, v45
    v_dot2c_f32_bf16 v34, v199, v44
    v_dot2c_f32_bf16 v35, v199, v45
    s_mov_b32 s3, 61440
    buffer_load_dwordx4 v[192:195], v1, s[48:51], s3 offen nt
    buffer_load_dwordx4 v[196:199], v1, s[48:51], s3 offen offset:256 nt
    s_waitcnt vmcnt(10)
    v_dot2c_f32_bf16 v20, v88, v46
    v_dot2c_f32_bf16 v21, v88, v47
    v_dot2c_f32_bf16 v28, v92, v46
    v_dot2c_f32_bf16 v29, v92, v47
    v_dot2c_f32_bf16 v22, v89, v46
    v_dot2c_f32_bf16 v23, v89, v47
    v_dot2c_f32_bf16 v30, v93, v46
    v_dot2c_f32_bf16 v31, v93, v47
    v_dot2c_f32_bf16 v24, v90, v46
    v_dot2c_f32_bf16 v25, v90, v47
    v_dot2c_f32_bf16 v32, v94, v46
    v_dot2c_f32_bf16 v33, v94, v47
    v_dot2c_f32_bf16 v26, v91, v46
    v_dot2c_f32_bf16 v27, v91, v47
    v_dot2c_f32_bf16 v34, v95, v46
    v_dot2c_f32_bf16 v35, v95, v47
    buffer_load_dwordx4 v[88:91], v1, s[48:51], s3 offen offset:2048 nt
    buffer_load_dwordx4 v[92:95], v1, s[48:51], s3 offen offset:2304 nt
    s_waitcnt vmcnt(10)
    v_dot2c_f32_bf16 v20, v224, v48
    v_dot2c_f32_bf16 v21, v224, v49
    v_dot2c_f32_bf16 v28, v228, v48
    v_dot2c_f32_bf16 v29, v228, v49
    v_dot2c_f32_bf16 v22, v225, v48
    v_dot2c_f32_bf16 v23, v225, v49
    v_dot2c_f32_bf16 v30, v229, v48
    v_dot2c_f32_bf16 v31, v229, v49
    v_dot2c_f32_bf16 v24, v226, v48
    v_dot2c_f32_bf16 v25, v226, v49
    v_dot2c_f32_bf16 v32, v230, v48
    v_dot2c_f32_bf16 v33, v230, v49
    v_dot2c_f32_bf16 v26, v227, v48
    v_dot2c_f32_bf16 v27, v227, v49
    v_dot2c_f32_bf16 v34, v231, v48
    v_dot2c_f32_bf16 v35, v231, v49
    s_waitcnt vmcnt(8)
    v_dot2c_f32_bf16 v20, v80, v50
    v_dot2c_f32_bf16 v21, v80, v51
    v_dot2c_f32_bf16 v28, v84, v50
    v_dot2c_f32_bf16 v29, v84, v51
    v_dot2c_f32_bf16 v22, v81, v50
    v_dot2c_f32_bf16 v23, v81, v51
    v_dot2c_f32_bf16 v30, v85, v50
    v_dot2c_f32_bf16 v31, v85, v51
    v_dot2c_f32_bf16 v24, v82, v50
    v_dot2c_f32_bf16 v25, v82, v51
    v_dot2c_f32_bf16 v32, v86, v50
    v_dot2c_f32_bf16 v33, v86, v51
    v_dot2c_f32_bf16 v26, v83, v50
    v_dot2c_f32_bf16 v27, v83, v51
    v_dot2c_f32_bf16 v34, v87, v50
    v_dot2c_f32_bf16 v35, v87, v51
    s_waitcnt vmcnt(6)
    v_dot2c_f32_bf16 v20, v128, v52
    v_dot2c_f32_bf16 v21, v128, v53
    v_dot2c_f32_bf16 v28, v132, v52
    v_dot2c_f32_bf16 v29, v132, v53
    v_dot2c_f32_bf16 v22, v129, v52
    v_dot2c_f32_bf16 v23, v129, v53
    v_dot2c_f32_bf16 v30, v133, v52
    v_dot2c_f32_bf16 v31, v133, v53
    v_dot2c_f32_bf16 v24, v130, v52
    v_dot2c_f32_bf16 v25, v130, v53
    v_dot2c_f32_bf16 v32, v134, v52
    v_dot2c_f32_bf16 v33, v134, v53
    v_dot2c_f32_bf16 v26, v131, v52
    v_dot2c_f32_bf16 v27, v131, v53
    v_dot2c_f32_bf16 v34, v135, v52
    v_dot2c_f32_bf16 v35, v135, v53
    s_waitcnt vmcnt(4)
    v_dot2c_f32_bf16 v20, v160, v54
    v_dot2c_f32_bf16 v21, v160, v55
    v_dot2c_f32_bf16 v28, v164, v54
    v_dot2c_f32_bf16 v29, v164, v55
    v_dot2c_f32_bf16 v22, v161, v54
    v_dot2c_f32_bf16 v23, v161, v55
    v_dot2c_f32_bf16 v30, v165, v54
    v_dot2c_f32_bf16 v31, v165, v55
    v_dot2c_f32_bf16 v24, v162, v54
    v_dot2c_f32_bf16 v25, v162, v55
    v_dot2c_f32_bf16 v32, v166, v54
    v_dot2c_f32_bf16 v33, v166, v55
    v_dot2c_f32_bf16 v26, v163, v54
    v_dot2c_f32_bf16 v27, v163, v55
    v_dot2c_f32_bf16 v34, v167, v54
    v_dot2c_f32_bf16 v35, v167, v55
    s_waitcnt vmcnt(2)
    v_dot2c_f32_bf16 v20, v192, v56
    v_dot2c_f32_bf16 v21, v192, v57
    v_dot2c_f32_bf16 v28, v196, v56
    v_dot2c_f32_bf16 v29, v196, v57
    v_dot2c_f32_bf16 v22, v193, v56
    v_dot2c_f32_bf16 v23, v193, v57
    v_dot2c_f32_bf16 v30, v197, v56
    v_dot2c_f32_bf16 v31, v197, v57
    v_dot2c_f32_bf16 v24, v194, v56
    v_dot2c_f32_bf16 v25, v194, v57
    v_dot2c_f32_bf16 v32, v198, v56
    v_dot2c_f32_bf16 v33, v198, v57
    v_dot2c_f32_bf16 v26, v195, v56
    v_dot2c_f32_bf16 v27, v195, v57
    v_dot2c_f32_bf16 v34, v199, v56
    v_dot2c_f32_bf16 v35, v199, v57
    s_waitcnt vmcnt(0)
    v_dot2c_f32_bf16 v20, v88, v58
    v_dot2c_f32_bf16 v21, v88, v59
    v_dot2c_f32_bf16 v28, v92, v58
    v_dot2c_f32_bf16 v29, v92, v59
    v_dot2c_f32_bf16 v22, v89, v58
    v_dot2c_f32_bf16 v23, v89, v59
    v_dot2c_f32_bf16 v30, v93, v58
    v_dot2c_f32_bf16 v31, v93, v59
    v_dot2c_f32_bf16 v24, v90, v58
    v_dot2c_f32_bf16 v25, v90, v59
    v_dot2c_f32_bf16 v32, v94, v58
    v_dot2c_f32_bf16 v33, v94, v59
    v_dot2c_f32_bf16 v26, v91, v58
    v_dot2c_f32_bf16 v27, v91, v59
    v_dot2c_f32_bf16 v34, v95, v58
    v_dot2c_f32_bf16 v35, v95, v59
    v_mov_b32 v4, v60
    v_mov_b32 v5, v4
    s_nop 1
    v_permlane16_swap_b32 v4, v5
    v_max_f32 v4, v4, v5
    v_mov_b32 v5, v4
    s_nop 1
    v_permlane32_swap_b32 v4, v5
    v_max_f32 v4, v4, v5
    v_sub_f32 v5, v60, v4
    v_mul_f32 v5, s14, v5
    v_exp_f32 v5, v5
    s_nop 0
    v_mul_f32 v61, v61, v5
    v_mul_f32 v20, v20, v5
    v_mul_f32 v21, v21, v5
    v_mul_f32 v22, v22, v5
    v_mul_f32 v23, v23, v5
    v_mul_f32 v24, v24, v5
    v_mul_f32 v25, v25, v5
    v_mul_f32 v26, v26, v5
    v_mul_f32 v27, v27, v5
    v_mul_f32 v28, v28, v5
    v_mul_f32 v29, v29, v5
    v_mul_f32 v30, v30, v5
    v_mul_f32 v31, v31, v5
    v_mul_f32 v32, v32, v5
    v_mul_f32 v33, v33, v5
    v_mul_f32 v34, v34, v5
    v_mul_f32 v35, v35, v5
    v_mov_b32 v6, v61
    s_nop 1
    v_permlane16_swap_b32 v61, v6
    v_add_f32 v61, v61, v6
    v_mov_b32 v6, v61
    s_nop 1
    v_permlane32_swap_b32 v61, v6
    v_add_f32 v61, v61, v6
    v_permlane32_swap_b32 v20, v28
    v_permlane32_swap_b32 v21, v29
    v_permlane32_swap_b32 v22, v30
    v_permlane32_swap_b32 v23, v31
    v_permlane32_swap_b32 v24, v32
    v_permlane32_swap_b32 v25, v33
    v_permlane32_swap_b32 v26, v34
    v_permlane32_swap_b32 v27, v35
    v_add_f32 v20, v20, v28
    v_add_f32 v21, v21, v29
    v_add_f32 v22, v22, v30
    v_add_f32 v23, v23, v31
    v_add_f32 v24, v24, v32
    v_add_f32 v25, v25, v33
    v_add_f32 v26, v26, v34
    v_add_f32 v27, v27, v35
    v_permlane16_swap_b32 v20, v24
    v_permlane16_swap_b32 v21, v25
    v_permlane16_swap_b32 v22, v26
    v_permlane16_swap_b32 v23, v27
    v_add_f32 v20, v20, v24
    v_add_f32 v21, v21, v25
    v_add_f32 v22, v22, v26
    v_add_f32 v23, v23, v27
    ds_write_b128 v71, v[20:23] offset:0
    v_mov_b32 v5, v61
    s_lshl_b32 s15, s4, 3
    v_mov_b32 v7, s15
    ds_write_b64 v7, v[4:5] offset:8192
    s_waitcnt lgkmcnt(0)
    s_cmp_ge_u32 s4, 4
    s_cbranch_scc1 K1_NOF2
    s_lshr_b32 s15, s10, 3
    s_lshl_b32 s88, s15, 2
    s_add_u32 s88, s88, 64
    v_mov_b32 v74, s88
    s_lshl_b32 s89, s4, 1
    s_lshl_b32 s3, s10, 3
    s_add_u32 s3, s3, s89
    s_mul_i32 s3, s3, 896
    v_add_u32 v4, s3, v65
    buffer_load_dwordx4 v[52:55], v4, s[68:71], 0 offen nt
    buffer_load_dwordx4 v[56:59], v4, s[68:71], 0 offen offset:896 nt
K1_FPOLL2:
    s_nop 3
    buffer_load_dword v72, v74, s[84:87], 0 offen sc0 sc1
    s_waitcnt vmcnt(0)
    v_readfirstlane_b32 s3, v72
    s_cmp_ge_u32 s3, 8
    s_cbranch_scc1 K1_FRDY2
    s_sleep 32
    s_branch K1_FPOLL2
K1_FRDY2:
    s_nop 3
    s_lshl_b32 s15, s15, 13
    s_and_b32 s3, s10, 7
    s_lshl_b32 s3, s3, 6
    s_add_u32 s15, s15, s3
    s_lshl_b32 s3, s4, 3
    s_add_u32 s15, s15, s3
    s_add_u32 s15, s15, 2392064
    v_and_b32 v4, 31, v62
    v_lshrrev_b32 v5, 2, v4
    v_lshlrev_b32 v5, 10, v5
    v_and_b32 v6, 2, v4
    v_lshl_add_u32 v5, v6, 8, v5
    v_and_b32 v6, 1, v4
    v_lshl_add_u32 v5, v6, 5, v5
    v_lshrrev_b32 v6, 5, v62
    v_lshl_add_u32 v5, v6, 2, v5
    v_add_u32 v75, s15, v5
    buffer_load_dword v73, v75, s[72:75], 0 offen sc0 sc1
    s_waitcnt vmcnt(0)
    s_nop 1
    v_add_f32_dpp v73, v73, v73 row_ror:4 row_mask:0xf bank_mask:0xf
    s_nop 1
    v_add_f32_dpp v73, v73, v73 row_ror:8 row_mask:0xf bank_mask:0xf
    v_mov_b32 v4, v73
    s_nop 1
    v_permlane16_swap_b32 v73, v4
    v_add_f32 v73, v73, v4
    s_nop 1
    v_mov_b32_dpp v72, v73 quad_perm:[2,3,0,1] row_mask:0xf bank_mask:0xf
    v_cvt_pk_bf16_f32 v73, 0, v73
    v_cvt_pk_bf16_f32 v72, 0, v72
    v_mul_f32 v5, 0xbfb8aa3b, v73
    v_exp_f32 v5, v5
    s_nop 0
    v_add_f32 v5, 1.0, v5
    v_rcp_f32 v6, v5
    s_nop 0
    v_mul_f32 v7, v73, v6
    v_fma_f32 v8, -v7, v5, v73
    v_fma_f32 v7, v8, v6, v7
    v_cvt_pk_bf16_f32 v7, 0, v7
    v_mul_f32 v7, v7, v72
    v_cvt_pk_bf16_f32 v73, 0, v7
    s_nop 0
    v_readlane_b32 s76, v73, 0
    s_nop 1
    s_lshr_b32 s77, s76, 16
    v_dot2_f32_bf16 v36, v52, s77, 0
    v_dot2_f32_bf16 v37, v52, s76, 0
    v_dot2_f32_bf16 v38, v53, s77, 0
    v_dot2_f32_bf16 v39, v53, s76, 0
    v_dot2_f32_bf16 v40, v54, s77, 0
    v_dot2_f32_bf16 v41, v54, s76, 0
    v_dot2_f32_bf16 v42, v55, s77, 0
    v_dot2_f32_bf16 v43, v55, s76, 0
    v_readlane_b32 s78, v73, 1
    s_nop 1
    s_lshr_b32 s79, s78, 16
    v_dot2_f32_bf16 v44, v52, s79, 0
    v_dot2_f32_bf16 v45, v52, s78, 0
    v_dot2_f32_bf16 v46, v53, s79, 0
    v_dot2_f32_bf16 v47, v53, s78, 0
    v_dot2_f32_bf16 v48, v54, s79, 0
    v_dot2_f32_bf16 v49, v54, s78, 0
    v_dot2_f32_bf16 v50, v55, s79, 0
    v_dot2_f32_bf16 v51, v55, s78, 0
    v_readlane_b32 s80, v73, 32
    s_nop 1
    s_lshr_b32 s81, s80, 16
    v_dot2_f32_bf16 v36, v56, s81, v36
    v_dot2_f32_bf16 v37, v56, s80, v37
    v_dot2_f32_bf16 v38, v57, s81, v38
    v_dot2_f32_bf16 v39, v57, s80, v39
    v_dot2_f32_bf16 v40, v58, s81, v40
    v_dot2_f32_bf16 v41, v58, s80, v41
    v_dot2_f32_bf16 v42, v59, s81, v42
    v_dot2_f32_bf16 v43, v59, s80, v43
    v_readlane_b32 s82, v73, 33
    s_nop 1
    s_lshr_b32 s83, s82, 16
    v_dot2_f32_bf16 v44, v56, s83, v44
    v_dot2_f32_bf16 v45, v56, s82, v45
    v_dot2_f32_bf16 v46, v57, s83, v46
    v_dot2_f32_bf16 v47, v57, s82, v47
    v_dot2_f32_bf16 v48, v58, s83, v48
    v_dot2_f32_bf16 v49, v58, s82, v49
    v_dot2_f32_bf16 v50, v59, s83, v50
    v_dot2_f32_bf16 v51, v59, s82, v51
    v_add_u32 v4, 76544, v68
    s_mov_b64 exec, s[6:7]
    ds_write_b128 v4, v[36:39]
    ds_write_b128 v4, v[40:43] offset:16
    ds_write_b128 v4, v[44:47] offset:1792
    ds_write_b128 v4, v[48:51] offset:1808
    s_mov_b64 exec, -1
    s_waitcnt lgkmcnt(0)
K1_NOF2:
    s_nop 3
    s_barrier
    v_mov_b32 v7, 0
    ds_read_b128 v[36:39], v7 offset:8192
    ds_read_b128 v[40:43], v7 offset:8208
    ds_read_b128 v[44:47], v7 offset:8224
    ds_read_b128 v[48:51], v7 offset:8240
    v_and_b32 v8, 31, v62
    s_lshl_b32 s15, s4, 7
    v_lshlrev_b32 v8, 2, v8
    v_add_u32 v8, s15, v8
    ds_read_b32 v52, v8 offset:0
    ds_read_b32 v53, v8 offset:1024
    ds_read_b32 v54, v8 offset:2048
    ds_read_b32 v55, v8 offset:3072
    ds_read_b32 v56, v8 offset:4096
    ds_read_b32 v57, v8 offset:5120
    ds_read_b32 v58, v8 offset:6144
    ds_read_b32 v59, v8 offset:7168
    s_waitcnt lgkmcnt(0)
    v_max3_f32 v4, v36, v38, v40
    v_max3_f32 v4, v4, v42, v44
    v_max3_f32 v4, v4, v46, v48
    v_max_f32 v4, v4, v50
    v_sub_f32 v36, v36, v4
    v_mul_f32 v36, s14, v36
    v_sub_f32 v38, v38, v4
    v_mul_f32 v38, s14, v38
    v_sub_f32 v40, v40, v4
    v_mul_f32 v40, s14, v40
    v_sub_f32 v42, v42, v4
    v_mul_f32 v42, s14, v42
    v_sub_f32 v44, v44, v4
    v_mul_f32 v44, s14, v44
    v_sub_f32 v46, v46, v4
    v_mul_f32 v46, s14, v46
    v_sub_f32 v48, v48, v4
    v_mul_f32 v48, s14, v48
    v_sub_f32 v50, v50, v4
    v_mul_f32 v50, s14, v50
    v_exp_f32 v36, v36
    v_exp_f32 v38, v38
    v_exp_f32 v40, v40
    v_exp_f32 v42, v42
    v_exp_f32 v44, v44
    v_exp_f32 v46, v46
    v_exp_f32 v48, v48
    v_exp_f32 v50, v50
    v_mul_f32 v5, v36, v37
    v_mul_f32 v6, v36, v52
    v_fmac_f32 v5, v38, v39
    v_fmac_f32 v6, v38, v53
    v_fmac_f32 v5, v40, v41
    v_fmac_f32 v6, v40, v54
    v_fmac_f32 v5, v42, v43
    v_fmac_f32 v6, v42, v55
    v_fmac_f32 v5, v44, v45
    v_fmac_f32 v6, v44, v56
    v_fmac_f32 v5, v46, v47
    v_fmac_f32 v6, v46, v57
    v_fmac_f32 v5, v48, v49
    v_fmac_f32 v6, v48, v58
    v_fmac_f32 v5, v50, v51
    v_fmac_f32 v6, v50, v59
    v_cvt_pk_bf16_f32 v6, 0, v6
    v_mov_b32 v20, 0
    v_mov_b32 v21, 0
    v_mov_b32 v22, 0
    v_mov_b32 v23, 0
    v_mov_b32 v24, 0
    v_mov_b32 v25, 0
    v_mov_b32 v26, 0
    v_mov_b32 v27, 0
    v_readlane_b32 s76, v6, 0
    s_nop 1
    s_lshr_b32 s77, s76, 16
    v_dot2c_f32_bf16 v20, s77, v96
    v_dot2c_f32_bf16 v21, s76, v96
    v_dot2c_f32_bf16 v22, s77, v97
    v_dot2c_f32_bf16 v23, s76, v97
    v_dot2c_f32_bf16 v24, s77, v98
    v_dot2c_f32_bf16 v25, s76, v98
    v_dot2c_f32_bf16 v26, s77, v99
    v_dot2c_f32_bf16 v27, s76, v99
    v_readlane_b32 s78, v6, 1
    s_nop 1
    s_lshr_b32 s79, s78, 16
    v_dot2c_f32_bf16 v20, s79, v100
    v_dot2c_f32_bf16 v21, s78, v100
    v_dot2c_f32_bf16 v22, s79, v101
    v_dot2c_f32_bf16 v23, s78, v101
    v_dot2c_f32_bf16 v24, s79, v102
    v_dot2c_f32_bf16 v25, s78, v102
    v_dot2c_f32_bf16 v26, s79, v103
    v_dot2c_f32_bf16 v27, s78, v103
    v_readlane_b32 s80, v6, 2
    s_nop 1
    s_lshr_b32 s81, s80, 16
    v_dot2c_f32_bf16 v20, s81, v216
    v_dot2c_f32_bf16 v21, s80, v216
    v_dot2c_f32_bf16 v22, s81, v217
    v_dot2c_f32_bf16 v23, s80, v217
    v_dot2c_f32_bf16 v24, s81, v218
    v_dot2c_f32_bf16 v25, s80, v218
    v_dot2c_f32_bf16 v26, s81, v219
    v_dot2c_f32_bf16 v27, s80, v219
    v_readlane_b32 s82, v6, 3
    s_nop 1
    s_lshr_b32 s83, s82, 16
    v_dot2c_f32_bf16 v20, s83, v220
    v_dot2c_f32_bf16 v21, s82, v220
    v_dot2c_f32_bf16 v22, s83, v221
    v_dot2c_f32_bf16 v23, s82, v221
    v_dot2c_f32_bf16 v24, s83, v222
    v_dot2c_f32_bf16 v25, s82, v222
    v_dot2c_f32_bf16 v26, s83, v223
    v_dot2c_f32_bf16 v27, s82, v223
    v_readlane_b32 s76, v6, 4
    s_nop 1
    s_lshr_b32 s77, s76, 16
    v_dot2c_f32_bf16 v20, s77, v232
    v_dot2c_f32_bf16 v21, s76, v232
    v_dot2c_f32_bf16 v22, s77, v233
    v_dot2c_f32_bf16 v23, s76, v233
    v_dot2c_f32_bf16 v24, s77, v234
    v_dot2c_f32_bf16 v25, s76, v234
    v_dot2c_f32_bf16 v26, s77, v235
    v_dot2c_f32_bf16 v27, s76, v235
    v_readlane_b32 s78, v6, 5
    s_nop 1
    s_lshr_b32 s79, s78, 16
    v_dot2c_f32_bf16 v20, s79, v236
    v_dot2c_f32_bf16 v21, s78, v236
    v_dot2c_f32_bf16 v22, s79, v237
    v_dot2c_f32_bf16 v23, s78, v237
    v_dot2c_f32_bf16 v24, s79, v238
    v_dot2c_f32_bf16 v25, s78, v238
    v_dot2c_f32_bf16 v26, s79, v239
    v_dot2c_f32_bf16 v27, s78, v239
    v_readlane_b32 s80, v6, 6
    s_nop 1
    s_lshr_b32 s81, s80, 16
    v_dot2c_f32_bf16 v20, s81, v252
    v_dot2c_f32_bf16 v21, s80, v252
    v_dot2c_f32_bf16 v22, s81, v253
    v_dot2c_f32_bf16 v23, s80, v253
    v_dot2c_f32_bf16 v24, s81, v254
    v_dot2c_f32_bf16 v25, s80, v254
    v_dot2c_f32_bf16 v26, s81, v255
    v_dot2c_f32_bf16 v27, s80, v255
    v_readlane_b32 s82, v6, 7
    s_nop 1
    s_lshr_b32 s83, s82, 16
    v_dot2c_f32_bf16 v20, s83, v248
    v_dot2c_f32_bf16 v21, s82, v248
    v_dot2c_f32_bf16 v22, s83, v249
    v_dot2c_f32_bf16 v23, s82, v249
    v_dot2c_f32_bf16 v24, s83, v250
    v_dot2c_f32_bf16 v25, s82, v250
    v_dot2c_f32_bf16 v26, s83, v251
    v_dot2c_f32_bf16 v27, s82, v251
    v_readlane_b32 s76, v6, 8
    s_nop 1
    s_lshr_b32 s77, s76, 16
    v_dot2c_f32_bf16 v20, s77, v104
    v_dot2c_f32_bf16 v21, s76, v104
    v_dot2c_f32_bf16 v22, s77, v105
    v_dot2c_f32_bf16 v23, s76, v105
    v_dot2c_f32_bf16 v24, s77, v106
    v_dot2c_f32_bf16 v25, s76, v106
    v_dot2c_f32_bf16 v26, s77, v107
    v_dot2c_f32_bf16 v27, s76, v107
    v_readlane_b32 s78, v6, 9
    s_nop 1
    s_lshr_b32 s79, s78, 16
    v_dot2c_f32_bf16 v20, s79, v108
    v_dot2c_f32_bf16 v21, s78, v108
    v_dot2c_f32_bf16 v22, s79, v109
    v_dot2c_f32_bf16 v23, s78, v109
    v_dot2c_f32_bf16 v24, s79, v110
    v_dot2c_f32_bf16 v25, s78, v110
    v_dot2c_f32_bf16 v26, s79, v111
    v_dot2c_f32_bf16 v27, s78, v111
    v_readlane_b32 s80, v6, 10
    s_nop 1
    s_lshr_b32 s81, s80, 16
    v_dot2c_f32_bf16 v20, s81, v120
    v_dot2c_f32_bf16 v21, s80, v120
    v_dot2c_f32_bf16 v22, s81, v121
    v_dot2c_f32_bf16 v23, s80, v121
    v_dot2c_f32_bf16 v24, s81, v122
    v_dot2c_f32_bf16 v25, s80, v122
    v_dot2c_f32_bf16 v26, s81, v123
    v_dot2c_f32_bf16 v27, s80, v123
    v_readlane_b32 s82, v6, 11
    s_nop 1
    s_lshr_b32 s83, s82, 16
    v_dot2c_f32_bf16 v20, s83, v124
    v_dot2c_f32_bf16 v21, s82, v124
    v_dot2c_f32_bf16 v22, s83, v125
    v_dot2c_f32_bf16 v23, s82, v125
    v_dot2c_f32_bf16 v24, s83, v126
    v_dot2c_f32_bf16 v25, s82, v126
    v_dot2c_f32_bf16 v26, s83, v127
    v_dot2c_f32_bf16 v27, s82, v127
    v_readlane_b32 s76, v6, 12
    s_nop 1
    s_lshr_b32 s77, s76, 16
    v_dot2c_f32_bf16 v20, s77, v136
    v_dot2c_f32_bf16 v21, s76, v136
    v_dot2c_f32_bf16 v22, s77, v137
    v_dot2c_f32_bf16 v23, s76, v137
    v_dot2c_f32_bf16 v24, s77, v138
    v_dot2c_f32_bf16 v25, s76, v138
    v_dot2c_f32_bf16 v26, s77, v139
    v_dot2c_f32_bf16 v27, s76, v139
    v_readlane_b32 s78, v6, 13
    s_nop 1
    s_lshr_b32 s79, s78, 16
    v_dot2c_f32_bf16 v20, s79, v140
    v_dot2c_f32_bf16 v21, s78, v140
    v_dot2c_f32_bf16 v22, s79, v141
    v_dot2c_f32_bf16 v23, s78, v141
    v_dot2c_f32_bf16 v24, s79, v142
    v_dot2c_f32_bf16 v25, s78, v142
    v_dot2c_f32_bf16 v26, s79, v143
    v_dot2c_f32_bf16 v27, s78, v143
    v_readlane_b32 s80, v6, 14
    s_nop 1
    s_lshr_b32 s81, s80, 16
    v_dot2c_f32_bf16 v20, s81, v152
    v_dot2c_f32_bf16 v21, s80, v152
    v_dot2c_f32_bf16 v22, s81, v153
    v_dot2c_f32_bf16 v23, s80, v153
    v_dot2c_f32_bf16 v24, s81, v154
    v_dot2c_f32_bf16 v25, s80, v154
    v_dot2c_f32_bf16 v26, s81, v155
    v_dot2c_f32_bf16 v27, s80, v155
    v_readlane_b32 s82, v6, 15
    s_nop 1
    s_lshr_b32 s83, s82, 16
    v_dot2c_f32_bf16 v20, s83, v156
    v_dot2c_f32_bf16 v21, s82, v156
    v_dot2c_f32_bf16 v22, s83, v157
    v_dot2c_f32_bf16 v23, s82, v157
    v_dot2c_f32_bf16 v24, s83, v158
    v_dot2c_f32_bf16 v25, s82, v158
    v_dot2c_f32_bf16 v26, s83, v159
    v_dot2c_f32_bf16 v27, s82, v159
    v_readlane_b32 s76, v6, 16
    s_nop 1
    s_lshr_b32 s77, s76, 16
    v_dot2c_f32_bf16 v20, s77, v168
    v_dot2c_f32_bf16 v21, s76, v168
    v_dot2c_f32_bf16 v22, s77, v169
    v_dot2c_f32_bf16 v23, s76, v169
    v_dot2c_f32_bf16 v24, s77, v170
    v_dot2c_f32_bf16 v25, s76, v170
    v_dot2c_f32_bf16 v26, s77, v171
    v_dot2c_f32_bf16 v27, s76, v171
    v_readlane_b32 s78, v6, 17
    s_nop 1
    s_lshr_b32 s79, s78, 16
    v_dot2c_f32_bf16 v20, s79, v172
    v_dot2c_f32_bf16 v21, s78, v172
    v_dot2c_f32_bf16 v22, s79, v173
    v_dot2c_f32_bf16 v23, s78, v173
    v_dot2c_f32_bf16 v24, s79, v174
    v_dot2c_f32_bf16 v25, s78, v174
    v_dot2c_f32_bf16 v26, s79, v175
    v_dot2c_f32_bf16 v27, s78, v175
    v_readlane_b32 s80, v6, 18
    s_nop 1
    s_lshr_b32 s81, s80, 16
    v_dot2c_f32_bf16 v20, s81, v184
    v_dot2c_f32_bf16 v21, s80, v184
    v_dot2c_f32_bf16 v22, s81, v185
    v_dot2c_f32_bf16 v23, s80, v185
    v_dot2c_f32_bf16 v24, s81, v186
    v_dot2c_f32_bf16 v25, s80, v186
    v_dot2c_f32_bf16 v26, s81, v187
    v_dot2c_f32_bf16 v27, s80, v187
    v_readlane_b32 s82, v6, 19
    s_nop 1
    s_lshr_b32 s83, s82, 16
    v_dot2c_f32_bf16 v20, s83, v188
    v_dot2c_f32_bf16 v21, s82, v188
    v_dot2c_f32_bf16 v22, s83, v189
    v_dot2c_f32_bf16 v23, s82, v189
    v_dot2c_f32_bf16 v24, s83, v190
    v_dot2c_f32_bf16 v25, s82, v190
    v_dot2c_f32_bf16 v26, s83, v191
    v_dot2c_f32_bf16 v27, s82, v191
    v_readlane_b32 s76, v6, 20
    s_nop 1
    s_lshr_b32 s77, s76, 16
    v_dot2c_f32_bf16 v20, s77, v200
    v_dot2c_f32_bf16 v21, s76, v200
    v_dot2c_f32_bf16 v22, s77, v201
    v_dot2c_f32_bf16 v23, s76, v201
    v_dot2c_f32_bf16 v24, s77, v202
    v_dot2c_f32_bf16 v25, s76, v202
    v_dot2c_f32_bf16 v26, s77, v203
    v_dot2c_f32_bf16 v27, s76, v203
    v_readlane_b32 s78, v6, 21
    s_nop 1
    s_lshr_b32 s79, s78, 16
    v_dot2c_f32_bf16 v20, s79, v204
    v_dot2c_f32_bf16 v21, s78, v204
    v_dot2c_f32_bf16 v22, s79, v205
    v_dot2c_f32_bf16 v23, s78, v205
    v_dot2c_f32_bf16 v24, s79, v206
    v_dot2c_f32_bf16 v25, s78, v206
    v_dot2c_f32_bf16 v26, s79, v207
    v_dot2c_f32_bf16 v27, s78, v207
    v_readlane_b32 s80, v6, 22
    s_nop 1
    s_lshr_b32 s81, s80, 16
    v_dot2c_f32_bf16 v20, s81, v208
    v_dot2c_f32_bf16 v21, s80, v208
    v_dot2c_f32_bf16 v22, s81, v209
    v_dot2c_f32_bf16 v23, s80, v209
    v_dot2c_f32_bf16 v24, s81, v210
    v_dot2c_f32_bf16 v25, s80, v210
    v_dot2c_f32_bf16 v26, s81, v211
    v_dot2c_f32_bf16 v27, s80, v211
    v_readlane_b32 s82, v6, 23
    s_nop 1
    s_lshr_b32 s83, s82, 16
    v_dot2c_f32_bf16 v20, s83, v212
    v_dot2c_f32_bf16 v21, s82, v212
    v_dot2c_f32_bf16 v22, s83, v213
    v_dot2c_f32_bf16 v23, s82, v213
    v_dot2c_f32_bf16 v24, s83, v214
    v_dot2c_f32_bf16 v25, s82, v214
    v_dot2c_f32_bf16 v26, s83, v215
    v_dot2c_f32_bf16 v27, s82, v215
    v_readlane_b32 s76, v6, 24
    s_nop 1
    s_lshr_b32 s77, s76, 16
    v_dot2c_f32_bf16 v20, s77, v240
    v_dot2c_f32_bf16 v21, s76, v240
    v_dot2c_f32_bf16 v22, s77, v241
    v_dot2c_f32_bf16 v23, s76, v241
    v_dot2c_f32_bf16 v24, s77, v242
    v_dot2c_f32_bf16 v25, s76, v242
    v_dot2c_f32_bf16 v26, s77, v243
    v_dot2c_f32_bf16 v27, s76, v243
    v_readlane_b32 s78, v6, 25
    s_nop 1
    s_lshr_b32 s79, s78, 16
    v_dot2c_f32_bf16 v20, s79, v244
    v_dot2c_f32_bf16 v21, s78, v244
    v_dot2c_f32_bf16 v22, s79, v245
    v_dot2c_f32_bf16 v23, s78, v245
    v_dot2c_f32_bf16 v24, s79, v246
    v_dot2c_f32_bf16 v25, s78, v246
    v_dot2c_f32_bf16 v26, s79, v247
    v_dot2c_f32_bf16 v27, s78, v247
    v_readlane_b32 s80, v6, 26
    s_nop 1
    s_lshr_b32 s81, s80, 16
    v_dot2c_f32_bf16 v20, s81, v112
    v_dot2c_f32_bf16 v21, s80, v112
    v_dot2c_f32_bf16 v22, s81, v113
    v_dot2c_f32_bf16 v23, s80, v113
    v_dot2c_f32_bf16 v24, s81, v114
    v_dot2c_f32_bf16 v25, s80, v114
    v_dot2c_f32_bf16 v26, s81, v115
    v_dot2c_f32_bf16 v27, s80, v115
    v_readlane_b32 s82, v6, 27
    s_nop 1
    s_lshr_b32 s83, s82, 16
    v_dot2c_f32_bf16 v20, s83, v116
    v_dot2c_f32_bf16 v21, s82, v116
    v_dot2c_f32_bf16 v22, s83, v117
    v_dot2c_f32_bf16 v23, s82, v117
    v_dot2c_f32_bf16 v24, s83, v118
    v_dot2c_f32_bf16 v25, s82, v118
    v_dot2c_f32_bf16 v26, s83, v119
    v_dot2c_f32_bf16 v27, s82, v119
    v_readlane_b32 s76, v6, 28
    s_nop 1
    s_lshr_b32 s77, s76, 16
    v_dot2c_f32_bf16 v20, s77, v144
    v_dot2c_f32_bf16 v21, s76, v144
    v_dot2c_f32_bf16 v22, s77, v145
    v_dot2c_f32_bf16 v23, s76, v145
    v_dot2c_f32_bf16 v24, s77, v146
    v_dot2c_f32_bf16 v25, s76, v146
    v_dot2c_f32_bf16 v26, s77, v147
    v_dot2c_f32_bf16 v27, s76, v147
    v_readlane_b32 s78, v6, 29
    s_nop 1
    s_lshr_b32 s79, s78, 16
    v_dot2c_f32_bf16 v20, s79, v148
    v_dot2c_f32_bf16 v21, s78, v148
    v_dot2c_f32_bf16 v22, s79, v149
    v_dot2c_f32_bf16 v23, s78, v149
    v_dot2c_f32_bf16 v24, s79, v150
    v_dot2c_f32_bf16 v25, s78, v150
    v_dot2c_f32_bf16 v26, s79, v151
    v_dot2c_f32_bf16 v27, s78, v151
    v_readlane_b32 s80, v6, 30
    s_nop 1
    s_lshr_b32 s81, s80, 16
    v_dot2c_f32_bf16 v20, s81, v176
    v_dot2c_f32_bf16 v21, s80, v176
    v_dot2c_f32_bf16 v22, s81, v177
    v_dot2c_f32_bf16 v23, s80, v177
    v_dot2c_f32_bf16 v24, s81, v178
    v_dot2c_f32_bf16 v25, s80, v178
    v_dot2c_f32_bf16 v26, s81, v179
    v_dot2c_f32_bf16 v27, s80, v179
    v_readlane_b32 s82, v6, 31
    s_nop 1
    s_lshr_b32 s83, s82, 16
    v_dot2c_f32_bf16 v20, s83, v180
    v_dot2c_f32_bf16 v21, s82, v180
    v_dot2c_f32_bf16 v22, s83, v181
    v_dot2c_f32_bf16 v23, s82, v181
    v_dot2c_f32_bf16 v24, s83, v182
    v_dot2c_f32_bf16 v25, s82, v182
    v_dot2c_f32_bf16 v26, s83, v183
    v_dot2c_f32_bf16 v27, s82, v183
    s_mul_i32 s15, s4, 1792
    v_lshlrev_b32 v7, 5, v62
    v_add_u32 v7, s15, v7
    s_mov_b64 exec, s[6:7]
    ds_write_b128 v7, v[20:23] offset:8448
    ds_write_b128 v7, v[24:27] offset:8464
    s_mov_b64 exec, -1
    s_waitcnt lgkmcnt(0)
    s_barrier
    s_cmp_ge_u32 s4, 7
    s_cbranch_scc1 K1_ML
    v_lshlrev_b32 v7, 2, v0
    ds_read_b32 v36, v7 offset:8448
    ds_read_b32 v37, v7 offset:10240
    ds_read_b32 v38, v7 offset:12032
    ds_read_b32 v39, v7 offset:13824
    ds_read_b32 v40, v7 offset:15616
    ds_read_b32 v41, v7 offset:17408
    ds_read_b32 v42, v7 offset:19200
    ds_read_b32 v43, v7 offset:20992
    s_waitcnt lgkmcnt(0)
    v_add_f32 v36, v36, v37
    v_add_f32 v36, v36, v38
    v_add_f32 v36, v36, v39
    v_add_f32 v36, v36, v40
    v_add_f32 v36, v36, v41
    v_add_f32 v36, v36, v42
    v_add_f32 v36, v36, v43
    s_mul_i32 s15, s13, 1792
    buffer_store_dword v36, v7, s[72:75], s15 offen
    s_cmp_ge_u32 s2, 224
    s_cbranch_scc1 K1_END
    v_add_u32 v9, 76544, v7
    ds_read_b32 v44, v9 offset:0
    ds_read_b32 v45, v9 offset:3584
    ds_read_b32 v46, v9 offset:7168
    ds_read_b32 v47, v9 offset:10752
    ds_read_b32 v52, v9 offset:1792
    ds_read_b32 v53, v9 offset:5376
    ds_read_b32 v54, v9 offset:8960
    ds_read_b32 v55, v9 offset:12544
    s_waitcnt lgkmcnt(0)
    v_add_f32 v44, v44, v45
    v_add_f32 v52, v52, v53
    v_add_f32 v44, v44, v46
    v_add_f32 v52, v52, v54
    v_add_f32 v44, v44, v47
    v_add_f32 v52, v52, v55
    s_mul_i32 s15, s10, 3584
    s_add_u32 s15, s15, 1048576
    buffer_store_dword v44, v7, s[72:75], s15 offen
    buffer_store_dword v52, v7, s[72:75], s15 offen offset:1792
    s_branch K1_END
K1_ML:
    s_nop 3
    s_lshl_b32 s15, s13, 3
    s_add_u32 s15, s15, 524288
    v_mov_b32 v7, 0
    s_mov_b64 exec, 1
    buffer_store_dwordx2 v[4:5], v7, s[72:75], s15 offen
K1_END:
    s_nop 3
    s_endpgm
.p2align 8
.globl k2_kernel
.type k2_kernel,@function
k2_kernel:
    s_cmp_ge_u32 s2, 56
    s_cbranch_scc1 K2_END
    s_load_dwordx2 s[16:17], s[0:1], 0
    s_load_dwordx2 s[18:19], s[0:1], 72
    s_load_dwordx2 s[20:21], s[0:1], 88
    s_cmp_ge_u32 s2, 28
    s_cselect_b32 s4, 1, 0
    s_mul_i32 s6, s4, 28
    s_sub_u32 s5, s2, s6
    s_mov_b32 s14, 0x3db8aa3b
    v_and_b32 v1, 3, v0
    v_lshrrev_b32 v2, 2, v0
    s_lshl_b32 s6, s5, 6
    v_lshl_add_u32 v3, v1, 4, s6
    s_lshl_b32 s7, s4, 7
    v_add_u32 v4, s7, v2
    s_mov_b32 s8, 1792
    v_mul_lo_u32 v4, s8, v4
    v_add_u32 v4, v4, v3
    s_mov_b32 s8, 3584
    v_mul_lo_u32 v5, s8, v2
    s_mul_i32 s9, s4, 1792
    v_add3_u32 v5, v5, v3, s9
    v_add_u32 v6, s7, v0
    v_lshlrev_b32 v6, 3, v6
    s_waitcnt lgkmcnt(0)
    s_mov_b32 s24, s16
    s_and_b32 s25, s17, 0xffff
    s_mov_b32 s26, 0x700
    s_mov_b32 s27, 0x00020000
    s_mov_b32 s28, s18
    s_and_b32 s29, s19, 0xffff
    s_mov_b32 s30, 0x700
    s_mov_b32 s31, 0x00020000
    s_mov_b32 s32, s20
    s_and_b32 s33, s21, 0xffff
    s_mov_b32 s34, 0x100000
    s_mov_b32 s35, 0x00020000
    s_add_u32 s22, s20, 0x100000
    s_addc_u32 s23, s21, 0
    s_mov_b32 s36, s22
    s_and_b32 s37, s23, 0xffff
    s_mov_b32 s38, 0xc4000
    s_mov_b32 s39, 0x00020000
    s_mov_b32 s10, 0x80000
    buffer_load_dwordx2 v[8:9], v6, s[32:35], s10 offen
    buffer_load_dwordx4 v[12:15], v4, s[32:35], 0 offen
    s_mov_b32 s10, 114688
    buffer_load_dwordx4 v[16:19], v4, s[32:35], s10 offen
    buffer_load_dwordx4 v[20:23], v5, s[36:39], 0 offen
    s_mov_b32 s10, 229376
    buffer_load_dwordx4 v[24:27], v5, s[36:39], s10 offen
    s_mov_b32 s10, 458752
    buffer_load_dwordx4 v[28:31], v5, s[36:39], s10 offen
    s_mov_b32 s10, 688128
    buffer_load_dwordx4 v[32:35], v5, s[36:39], s10 offen
    s_mul_i32 s11, s4, 896
    s_lshl_b32 s12, s5, 5
    s_add_u32 s11, s11, s12
    v_lshlrev_b32 v7, 1, v0
    v_add_u32 v7, s11, v7
    buffer_load_ushort v10, v7, s[24:27], 0 offen
    s_waitcnt vmcnt(7)
    v_mov_b32 v36, v8
    s_nop 1
    v_max_f32_dpp v36, v36, v36 quad_perm:[1,0,3,2] row_mask:0xf bank_mask:0xf
    s_nop 1
    v_max_f32_dpp v36, v36, v36 quad_perm:[2,3,0,1] row_mask:0xf bank_mask:0xf
    s_nop 1
    v_max_f32_dpp v36, v36, v36 row_half_mirror row_mask:0xf bank_mask:0xf
    v_sub_f32 v37, v8, v36
    v_mul_f32 v37, s14, v37
    v_exp_f32 v37, v37
    s_nop 0
    v_mul_f32 v38, v37, v9
    s_nop 1
    v_add_f32_dpp v38, v38, v38 quad_perm:[1,0,3,2] row_mask:0xf bank_mask:0xf
    s_nop 1
    v_add_f32_dpp v38, v38, v38 quad_perm:[2,3,0,1] row_mask:0xf bank_mask:0xf
    s_nop 1
    v_add_f32_dpp v38, v38, v38 row_half_mirror row_mask:0xf bank_mask:0xf
    v_rcp_f32 v39, v38
    s_nop 0
    v_mul_f32 v40, v37, v39
    v_fma_f32 v41, -v40, v38, v37
    v_fma_f32 v40, v41, v39, v40
    v_lshlrev_b32 v42, 2, v0
    v_cmp_gt_u32 vcc, 0x80, v0
    s_nop 1
    s_and_saveexec_b64 s[40:41], vcc
    ds_write_b32 v42, v40
    s_mov_b64 exec, s[40:41]
    s_waitcnt lgkmcnt(0)
    s_barrier
    v_lshlrev_b32 v42, 2, v2
    ds_read_b32 v43, v42
    ds_read_b32 v44, v42 offset:256
    s_waitcnt lgkmcnt(0)
    s_waitcnt vmcnt(5)
    v_mul_f32 v12, v12, v43
    v_fmac_f32 v12, v16, v44
    v_mul_f32 v13, v13, v43
    v_fmac_f32 v13, v17, v44
    v_mul_f32 v14, v14, v43
    v_fmac_f32 v14, v18, v44
    v_mul_f32 v15, v15, v43
    v_fmac_f32 v15, v19, v44
    s_waitcnt vmcnt(1)
    v_add_f32 v20, v20, v24
    v_add_f32 v28, v28, v32
    v_add_f32 v16, v20, v28
    v_add_f32 v21, v21, v25
    v_add_f32 v29, v29, v33
    v_add_f32 v17, v21, v29
    v_add_f32 v22, v22, v26
    v_add_f32 v30, v30, v34
    v_add_f32 v18, v22, v30
    v_add_f32 v23, v23, v27
    v_add_f32 v31, v31, v35
    v_add_f32 v19, v23, v31
    v_add_f32_dpp v12, v12, v12 row_ror:4 row_mask:0xf bank_mask:0xf
    v_add_f32_dpp v13, v13, v13 row_ror:4 row_mask:0xf bank_mask:0xf
    v_add_f32_dpp v14, v14, v14 row_ror:4 row_mask:0xf bank_mask:0xf
    v_add_f32_dpp v15, v15, v15 row_ror:4 row_mask:0xf bank_mask:0xf
    v_add_f32_dpp v16, v16, v16 row_ror:4 row_mask:0xf bank_mask:0xf
    v_add_f32_dpp v17, v17, v17 row_ror:4 row_mask:0xf bank_mask:0xf
    v_add_f32_dpp v18, v18, v18 row_ror:4 row_mask:0xf bank_mask:0xf
    v_add_f32_dpp v19, v19, v19 row_ror:4 row_mask:0xf bank_mask:0xf
    v_add_f32_dpp v12, v12, v12 row_ror:8 row_mask:0xf bank_mask:0xf
    v_add_f32_dpp v13, v13, v13 row_ror:8 row_mask:0xf bank_mask:0xf
    v_add_f32_dpp v14, v14, v14 row_ror:8 row_mask:0xf bank_mask:0xf
    v_add_f32_dpp v15, v15, v15 row_ror:8 row_mask:0xf bank_mask:0xf
    v_add_f32_dpp v16, v16, v16 row_ror:8 row_mask:0xf bank_mask:0xf
    v_add_f32_dpp v17, v17, v17 row_ror:8 row_mask:0xf bank_mask:0xf
    v_add_f32_dpp v18, v18, v18 row_ror:8 row_mask:0xf bank_mask:0xf
    v_add_f32_dpp v19, v19, v19 row_ror:8 row_mask:0xf bank_mask:0xf
    v_mov_b32 v45, v12
    s_nop 1
    v_permlane16_swap_b32 v12, v45
    v_add_f32 v12, v12, v45
    v_mov_b32 v45, v12
    s_nop 1
    v_permlane32_swap_b32 v12, v45
    v_add_f32 v12, v12, v45
    v_mov_b32 v46, v13
    s_nop 1
    v_permlane16_swap_b32 v13, v46
    v_add_f32 v13, v13, v46
    v_mov_b32 v46, v13
    s_nop 1
    v_permlane32_swap_b32 v13, v46
    v_add_f32 v13, v13, v46
    v_mov_b32 v45, v14
    s_nop 1
    v_permlane16_swap_b32 v14, v45
    v_add_f32 v14, v14, v45
    v_mov_b32 v45, v14
    s_nop 1
    v_permlane32_swap_b32 v14, v45
    v_add_f32 v14, v14, v45
    v_mov_b32 v46, v15
    s_nop 1
    v_permlane16_swap_b32 v15, v46
    v_add_f32 v15, v15, v46
    v_mov_b32 v46, v15
    s_nop 1
    v_permlane32_swap_b32 v15, v46
    v_add_f32 v15, v15, v46
    v_mov_b32 v45, v16
    s_nop 1
    v_permlane16_swap_b32 v16, v45
    v_add_f32 v16, v16, v45
    v_mov_b32 v45, v16
    s_nop 1
    v_permlane32_swap_b32 v16, v45
    v_add_f32 v16, v16, v45
    v_mov_b32 v46, v17
    s_nop 1
    v_permlane16_swap_b32 v17, v46
    v_add_f32 v17, v17, v46
    v_mov_b32 v46, v17
    s_nop 1
    v_permlane32_swap_b32 v17, v46
    v_add_f32 v17, v17, v46
    v_mov_b32 v45, v18
    s_nop 1
    v_permlane16_swap_b32 v18, v45
    v_add_f32 v18, v18, v45
    v_mov_b32 v45, v18
    s_nop 1
    v_permlane32_swap_b32 v18, v45
    v_add_f32 v18, v18, v45
    v_mov_b32 v46, v19
    s_nop 1
    v_permlane16_swap_b32 v19, v46
    v_add_f32 v19, v19, v46
    v_mov_b32 v46, v19
    s_nop 1
    v_permlane32_swap_b32 v19, v46
    v_add_f32 v19, v19, v46
    v_lshrrev_b32 v46, 6, v0
    v_lshlrev_b32 v46, 7, v46
    v_lshl_add_u32 v46, v1, 5, v46
    v_and_b32 v47, 63, v0
    v_cmp_gt_u32 vcc, 4, v47
    s_nop 1
    s_and_saveexec_b64 s[40:41], vcc
    ds_write_b128 v46, v[12:15] offset:1024
    ds_write_b128 v46, v[16:19] offset:1040
    s_mov_b64 exec, s[40:41]
    s_waitcnt lgkmcnt(0)
    s_barrier
    v_cmp_gt_u32 vcc, 16, v0
    s_nop 1
    s_and_saveexec_b64 s[40:41], vcc
    s_cbranch_execz K2_END
    v_lshlrev_b32 v46, 5, v2
    v_lshl_add_u32 v46, v1, 2, v46
    ds_read_b32 v12, v46 offset:1024
    ds_read_b32 v16, v46 offset:1040
    ds_read_b32 v13, v46 offset:1152
    ds_read_b32 v17, v46 offset:1168
    ds_read_b32 v14, v46 offset:1280
    ds_read_b32 v18, v46 offset:1296
    ds_read_b32 v15, v46 offset:1408
    ds_read_b32 v19, v46 offset:1424
    s_waitcnt lgkmcnt(0)
    v_add_f32 v12, v12, v13
    v_add_f32 v14, v14, v15
    v_add_f32 v12, v12, v14
    v_add_f32 v16, v16, v17
    v_add_f32 v18, v18, v19
    v_add_f32 v16, v16, v18
    v_cvt_pk_bf16_f32 v12, 0, v12
    v_cvt_pk_bf16_f32 v16, 0, v16
    s_waitcnt vmcnt(0)
    v_lshlrev_b32 v10, 16, v10
    v_add_f32 v10, v10, v12
    v_cvt_pk_bf16_f32 v10, 0, v10
    v_add_f32 v10, v10, v16
    v_cvt_pk_bf16_f32 v10, v10, 0
    buffer_store_short v10, v7, s[28:31], 0 offen
K2_END:
    s_nop 3
    s_endpgm
.section .rodata,"a"
.p2align 6
.amdhsa_kernel k1_kernel
  .amdhsa_next_free_vgpr 256
  .amdhsa_next_free_sgpr 102
  .amdhsa_accum_offset 256
  .amdhsa_group_segment_fixed_size 0
  .amdhsa_kernarg_size 96
  .amdhsa_user_sgpr_count 2
  .amdhsa_user_sgpr_kernarg_segment_ptr 1
  .amdhsa_system_sgpr_workgroup_id_x 1
.end_amdhsa_kernel
.p2align 6
.amdhsa_kernel k2_kernel
  .amdhsa_next_free_vgpr 64
  .amdhsa_next_free_sgpr 64
  .amdhsa_accum_offset 64
  .amdhsa_group_segment_fixed_size 0
  .amdhsa_kernarg_size 96
  .amdhsa_user_sgpr_count 2
  .amdhsa_user_sgpr_kernarg_segment_ptr 1
  .amdhsa_system_sgpr_workgroup_id_x 1
.end_amdhsa_kernel
```
